```python
import torch

def _softmax(x, axis=-1):
    return torch.softmax(x, dim=axis)
def _gelu(x):
    return torch.nn.functional.gelu(x, approximate="tanh")
def _silu(x):
    return torch.nn.functional.silu(x)
def _sigmoid(x):
    return torch.sigmoid(x)
def _layernorm(x, axis=-1, eps=1e-5):
    m = x.mean(dim=axis, keepdim=True)
    v = x.var(dim=axis, keepdim=True, unbiased=False)
    return (x - m) / torch.sqrt(v + eps)
def _scatter_add(tgt, idx, src, axis=0):
    return tgt.clone().index_add_(axis, idx, src)
def _segment_sum(src, seg, n):
    out = torch.zeros((n,) + src.shape[1:], dtype=src.dtype)
    return out.index_add_(0, seg, src)
def _pad(x, pw):
    flat = tuple(v for pair in reversed(pw) for v in pair)
    return torch.nn.functional.pad(x, flat)

kernel_name = 'standalone__mha_softmax__near_ridge'

def setup_inputs():

    _w = (lambda a: (lambda t: t.to(torch.bfloat16) if t.is_floating_point() else t)(torch.as_tensor(a)))
    B, H, Sq, Sk, D = 8, 32, 736, 512, 128
    return {
        "q": _w((lambda *s: torch.randn(*s, dtype=torch.bfloat16) * 0.8)(B, H, Sq, D)),
        "k": _w((lambda *s: torch.randn(*s, dtype=torch.bfloat16) * 0.8)(B, H, Sk, D)),
        "v": _w((lambda *s: torch.randn(*s, dtype=torch.bfloat16) * 0.05)(B, H, Sk, D)),
    }

def reference(q, k, v):
    scale = q.shape[-1] ** -0.5
    scores = torch.einsum("bhqd,bhkd->bhqk", q, k) * scale
    p = _softmax(scores, axis=-1)
    return torch.einsum("bhqk,bhkd->bhqd", p, v)
```

```asm
; @launch grid=(256,1,1) block=(256,1,1) lds=163840
.amdgcn_target "amdgcn-amd-amdhsa--gfx950"
.text
.globl standalone__mha_softmax__near_ridge_kernel
.p2align 8
.type standalone__mha_softmax__near_ridge_kernel,@function
standalone__mha_softmax__near_ridge_kernel:
    s_load_dwordx2 s[8:9], s[0:1], 8
    s_load_dwordx2 s[4:5], s[0:1], 0
    s_load_dwordx2 s[12:13], s[0:1], 16
    s_load_dwordx2 s[6:7], s[0:1], 24
    s_cmp_ge_u32 s2, 256
    s_cbranch_scc1 L_exit
    v_lshrrev_b32 v28, 6, v0
    v_and_b32 v1, 63, v0
    v_readfirstlane_b32 s3, v28
    v_bfe_u32 v28, v1, 2, 2
    v_lshlrev_b32 v28, 8, v28
    v_lshrrev_b32 v29, 4, v1
    v_lshl_or_b32 v28, v29, 6, v28
    v_and_b32 v29, 3, v1
    v_lshl_or_b32 v2, v29, 4, v28
    v_xor_b32 v3, 32, v2
    s_and_b32 s86, s2, 7
    s_lshl_b32 s86, s86, 5
    s_lshr_b32 s87, s2, 3
    s_add_u32 s54, s87, 0
    s_mul_i32 s55, s54, 171
    s_lshr_b32 s55, s55, 9
    s_mul_i32 s50, s55, 3
    s_sub_u32 s54, s54, s50
    s_add_u32 s55, s55, s86
    s_lshl_b32 s42, s55, 17
    s_mul_i32 s46, s55, 188416
    s_lshl_b32 s54, s54, 16
    s_add_u32 s46, s46, s54
    s_sub_u32 s50, 188416, s54
    s_min_u32 s50, s50, 0x10000
    s_lshl_b32 s32, s3, 12
    s_mov_b32 s10, 33554432
    s_mov_b32 s11, 0x20000
    s_mov_b32 s19, 0x20000
    s_add_u32 s35, s42, s32
    s_mov_b32 s38, s35
    s_mov_b32 m0, s32
    s_lshl_b32 s28, s3, 14
    s_add_u32 s29, s28, 4096
    s_add_u32 s58, s28, 98304
    s_add_u32 s59, s58, 4096
    s_getpc_b64 s[62:63]
L_pf:
    s_and_b32 s54, s87, 15
    s_lshl_b32 s54, s54, 2
    s_add_u32 s54, s54, s3
    s_lshl_b32 s54, s54, 10
    s_min_u32 s54, s54, L_fb-L_pf-1024
    v_lshl_add_u32 v38, v1, 4, s54
    global_load_dwordx4 v[60:63], v38, s[62:63]
    s_waitcnt lgkmcnt(0)
    buffer_load_dwordx4 v2, s[8:11], s38 offen offset:0 nt lds
    buffer_load_dwordx4 v2, s[8:11], s38 offen offset:1024 nt lds
    buffer_load_dwordx4 v3, s[8:11], s38 offen offset:2048 nt lds
    buffer_load_dwordx4 v3, s[8:11], s38 offen offset:3072 nt lds
    s_add_u32 s16, s4, s46
    s_addc_u32 s17, s5, 0
    s_mov_b32 s18, s50
    s_mov_b32 m0, s58
    s_nop 0
    buffer_load_dwordx4 v2, s[16:19], s28 offen offset:0 nt lds
    buffer_load_dwordx4 v2, s[16:19], s28 offen offset:1024 nt lds
    buffer_load_dwordx4 v3, s[16:19], s28 offen offset:2048 nt lds
    buffer_load_dwordx4 v3, s[16:19], s28 offen offset:3072 nt lds
    s_mov_b32 s14, 33554432
    s_mov_b32 s15, 0x20000
    s_mov_b32 s23, 0x20000
    s_add_u32 m0, s32, 49152
    s_nop 0
    buffer_load_dwordx4 v2, s[12:15], s38 offen offset:0 nt lds
    buffer_load_dwordx4 v3, s[12:15], s38 offen offset:1024 nt lds
    buffer_load_dwordx4 v2, s[12:15], s38 offen offset:2048 nt lds
    buffer_load_dwordx4 v3, s[12:15], s38 offen offset:3072 nt lds
    s_add_u32 s54, s87, 32
    s_mul_i32 s55, s54, 171
    s_lshr_b32 s55, s55, 9
    s_mul_i32 s51, s55, 3
    s_sub_u32 s54, s54, s51
    s_add_u32 s55, s55, s86
    s_lshl_b32 s43, s55, 17
    s_mul_i32 s47, s55, 188416
    s_lshl_b32 s54, s54, 16
    s_add_u32 s47, s47, s54
    s_sub_u32 s51, 188416, s54
    s_min_u32 s51, s51, 0x10000
    s_add_u32 s54, s87, 64
    s_mul_i32 s55, s54, 171
    s_lshr_b32 s55, s55, 9
    s_mul_i32 s52, s55, 3
    s_sub_u32 s54, s54, s52
    s_add_u32 s55, s55, s86
    s_lshl_b32 s44, s55, 17
    s_mul_i32 s48, s55, 188416
    s_lshl_b32 s54, s54, 16
    s_add_u32 s48, s48, s54
    s_sub_u32 s52, 188416, s54
    s_min_u32 s52, s52, 0x10000
    s_mov_b32 s45, 0x40000000
    s_mov_b32 s49, 0
    s_mov_b32 s53, 0
    s_mov_b32 s24, 0x3e0293ee
    s_add_u32 s33, s32, 49152
    s_add_u32 s30, s28, 8192
    s_add_u32 s60, s58, 8192
    s_add_u32 s31, s28, 12288
    s_add_u32 s61, s58, 12288
    s_mov_b32 s34, s58
    s_mov_b32 s41, 0
    s_mov_b32 s40, 0
    s_mov_b32 s25, 0
    s_mov_b32 s26, 16384
    s_mov_b32 s27, 32768
    s_add_u32 s36, s43, s32
    s_add_u32 s20, s6, s49
    s_addc_u32 s21, s7, 0
    s_mov_b32 s22, s53
    v_lshrrev_b32 v31, 4, v1
    v_bfe_u32 v28, v1, 3, 1
    v_lshlrev_b32 v28, 1, v28
    v_xor_b32 v28, v28, v31
    v_lshlrev_b32 v28, 4, v28
    v_bfe_u32 v29, v1, 2, 2
    v_lshl_or_b32 v28, v29, 10, v28
    v_and_b32 v30, 3, v1
    v_lshl_or_b32 v7, v30, 6, v28
    v_add_u32 v13, s34, v7
    v_lshlrev_b32 v28, 10, v31
    v_lshl_or_b32 v28, v29, 6, v28
    v_lshl_or_b32 v28, v30, 3, v28
    v_and_b32 v29, 1, v31
    v_lshl_or_b32 v28, v29, 5, v28
    v_add_u32 v8, 49152, v28
    v_xor_b32 v9, 32, v8
    v_lshrrev_b32 v28, 1, v31
    v_and_b32 v30, 7, v1
    v_xor_b32 v28, v28, v30
    v_lshlrev_b32 v28, 4, v28
    v_lshl_or_b32 v28, v29, 3, v28
    v_and_b32 v30, 15, v1
    v_lshl_or_b32 v28, v30, 8, v28
    v_add_u32 v15, s34, v28
    v_xor_b32 v16, 32, v15
    v_xor_b32 v17, 64, v15
    v_xor_b32 v18, 96, v15
    v_xor_b32 v30, v30, v31
    v_lshlrev_b32 v30, 4, v30
    v_lshl_or_b32 v30, v31, 8, v30
    v_add_u32 v19, s34, v30
    v_xor_b32 v20, 64, v19
    v_lshlrev_b32 v21, 4, v1
    v_mov_b32 v28, 0x3f803f80
    v_accvgpr_write_b32 a224, v28
    v_accvgpr_write_b32 a225, v28
    v_accvgpr_write_b32 a226, v28
    v_accvgpr_write_b32 a227, v28
    v_and_b32 v29, 1, v1
    v_mov_b32 v30, 0xaaaaaaaa
    v_mul_lo_u32 v29, v29, v30
    v_or_b32 v4, 0x44444444, v29
    v_accvgpr_write_b32 a228, 0
    v_accvgpr_write_b32 a229, 0
    v_accvgpr_write_b32 a230, 0
    v_accvgpr_write_b32 a231, 0
    v_accvgpr_write_b32 a232, 0
    v_accvgpr_write_b32 a233, 0
    v_accvgpr_write_b32 a234, 0
    v_accvgpr_write_b32 a235, 0
    v_accvgpr_write_b32 a236, 0
    v_accvgpr_write_b32 a237, 0
    v_accvgpr_write_b32 a238, 0
    v_accvgpr_write_b32 a239, 0
    v_accvgpr_write_b32 a240, 0
    v_accvgpr_write_b32 a241, 0
    v_accvgpr_write_b32 a242, 0
    v_accvgpr_write_b32 a243, 0
    v_bfe_u32 v28, v1, 2, 2
    v_xor_b32 v28, v28, v31
    v_lshlrev_b32 v28, 1, v28
    v_bfe_u32 v29, v1, 1, 1
    v_or_b32 v28, v28, v29
    v_and_b32 v29, 1, v1
    v_lshlrev_b32 v29, 4, v29
    v_mov_b32 v30, 0x3e03
    v_lshlrev_b32 v30, v29, v30
    v_cmp_eq_u32 vcc, 0, v28
    s_nop 1
    v_cndmask_b32 v32, 0, v30, vcc
    v_accvgpr_write_b32 a244, v32
    v_cmp_eq_u32 vcc, 1, v28
    s_nop 1
    v_cndmask_b32 v32, 0, v30, vcc
    v_accvgpr_write_b32 a245, v32
    v_mov_b32 v30, 0xb9d8
    v_lshlrev_b32 v30, v29, v30
    v_cmp_eq_u32 vcc, 0, v28
    s_nop 1
    v_cndmask_b32 v32, 0, v30, vcc
    v_accvgpr_write_b32 a246, v32
    v_cmp_eq_u32 vcc, 1, v28
    s_nop 1
    v_cndmask_b32 v32, 0, v30, vcc
    v_accvgpr_write_b32 a247, v32
    v_add_u32 v10, 16384, v7
    v_add_u32 v11, 16384, v8
    v_add_u32 v12, 16384, v9
    s_mov_b32 m0, s59
    s_nop 0
    buffer_load_dwordx4 v2, s[16:19], s29 offen offset:0 nt lds
    buffer_load_dwordx4 v2, s[16:19], s29 offen offset:1024 nt lds
    buffer_load_dwordx4 v3, s[16:19], s29 offen offset:2048 nt lds
    buffer_load_dwordx4 v3, s[16:19], s29 offen offset:3072 nt lds
    s_mov_b32 m0, s60
    s_waitcnt vmcnt(12)
    s_barrier
    ds_read_b128 a[64:67], v7 offset:4096
    ds_read_b128 a[68:71], v7 offset:4352
    ds_read_b128 a[72:75], v7 offset:4608
    ds_read_b128 a[76:79], v7 offset:4864
    ds_read_b128 a[80:83], v7 offset:0
    ds_read_b128 a[84:87], v7 offset:256
    ds_read_b128 a[88:91], v7 offset:512
    ds_read_b128 a[92:95], v7 offset:768
    ds_read_b128 a[96:99], v7 offset:8192
    ds_read_b128 a[100:103], v7 offset:8448
    ds_read_b128 a[104:107], v7 offset:8704
    ds_read_b128 a[108:111], v7 offset:8960
    ds_read_b128 a[112:115], v7 offset:12288
    ds_read_b128 a[116:119], v7 offset:12544
    ds_read_b128 a[120:123], v7 offset:12800
    ds_read_b128 a[124:127], v7 offset:13056
    s_waitcnt vmcnt(8)
    ds_read_b64 a[0:1], v13 offset:0
    ds_read_b64 a[2:3], v13 offset:0
    ds_read_b64 a[216:217], v13 offset:8
    ds_read_b64 a[218:219], v13 offset:8
    ds_read_b64 a[4:5], v13 offset:256
    ds_read_b64 a[6:7], v13 offset:256
    ds_read_b64 a[220:221], v13 offset:264
    ds_read_b64 a[222:223], v13 offset:264
    ds_read_b64 a[8:9], v13 offset:512
    ds_read_b64 a[10:11], v13 offset:512
    ds_read_b64 a[248:249], v13 offset:520
    ds_read_b64 a[250:251], v13 offset:520
    ds_read_b64 a[12:13], v13 offset:768
    ds_read_b64 a[14:15], v13 offset:768
    ds_read_b64 a[252:253], v13 offset:776
    ds_read_b64 a[254:255], v13 offset:776
    s_waitcnt lgkmcnt(14)
    v_mfma_f32_16x16x32_bf16 v[28:31], a[244:247], a[0:3], 0
    s_waitcnt lgkmcnt(12)
    v_mfma_f32_16x16x32_bf16 v[32:35], a[244:247], a[216:219], 0
    s_waitcnt lgkmcnt(10)
    v_mfma_f32_16x16x32_bf16 v[36:39], a[244:247], a[4:7], 0
    s_waitcnt lgkmcnt(8)
    v_mfma_f32_16x16x32_bf16 v[40:43], a[244:247], a[220:223], 0
    v_cvt_pk_bf16_f32 v28, v28, v29
    v_cvt_pk_bf16_f32 v29, v30, v31
    v_accvgpr_write_b32 a0, v28
    v_accvgpr_write_b32 a1, v29
    s_waitcnt lgkmcnt(6)
    v_mfma_f32_16x16x32_bf16 v[28:31], a[244:247], a[8:11], 0
    v_cvt_pk_bf16_f32 v32, v32, v33
    v_cvt_pk_bf16_f32 v33, v34, v35
    v_accvgpr_write_b32 a2, v32
    v_accvgpr_write_b32 a3, v33
    s_waitcnt lgkmcnt(4)
    v_mfma_f32_16x16x32_bf16 v[32:35], a[244:247], a[248:251], 0
    v_cvt_pk_bf16_f32 v36, v36, v37
    v_cvt_pk_bf16_f32 v37, v38, v39
    v_accvgpr_write_b32 a4, v36
    v_accvgpr_write_b32 a5, v37
    s_waitcnt lgkmcnt(2)
    v_mfma_f32_16x16x32_bf16 v[36:39], a[244:247], a[12:15], 0
    v_cvt_pk_bf16_f32 v40, v40, v41
    v_cvt_pk_bf16_f32 v41, v42, v43
    v_accvgpr_write_b32 a6, v40
    v_accvgpr_write_b32 a7, v41
    s_waitcnt lgkmcnt(0)
    v_mfma_f32_16x16x32_bf16 v[40:43], a[244:247], a[252:255], 0
    v_cvt_pk_bf16_f32 v28, v28, v29
    v_cvt_pk_bf16_f32 v29, v30, v31
    v_mfma_f32_16x16x32_bf16 v[68:71], a[64:67], a[0:3], 0
    v_cvt_pk_bf16_f32 v32, v32, v33
    v_cvt_pk_bf16_f32 v33, v34, v35
    v_mfma_f32_16x16x32_bf16 v[68:71], a[68:71], a[4:7], v[68:71]
    s_waitcnt vmcnt(4)
    s_barrier
    v_accvgpr_write_b32 a8, v28
    v_accvgpr_write_b32 a10, v32
    v_accvgpr_write_b32 a9, v29
    v_accvgpr_write_b32 a11, v33
    s_nop 1
    v_mfma_f32_16x16x32_bf16 v[68:71], a[72:75], a[8:11], v[68:71]
    buffer_load_dwordx4 v2, s[16:19], s30 offen offset:0 nt lds
    v_cvt_pk_bf16_f32 v36, v36, v37
    v_cvt_pk_bf16_f32 v40, v40, v41
    v_cvt_pk_bf16_f32 v37, v38, v39
    v_cvt_pk_bf16_f32 v41, v42, v43
    v_accvgpr_write_b32 a12, v36
    v_accvgpr_write_b32 a14, v40
    v_accvgpr_write_b32 a13, v37
    v_accvgpr_write_b32 a15, v41
    s_nop 1
    v_mfma_f32_16x16x32_bf16 v[68:71], a[76:79], a[12:15], v[68:71]
    ds_read_b64_tr_b16 a[128:129], v8 offset:0
    ds_read_b64_tr_b16 a[130:131], v8 offset:4096
    v_mfma_f32_16x16x32_bf16 v[64:67], a[80:83], a[0:3], 0
    ds_read_b64_tr_b16 a[160:161], v8 offset:8192
    ds_read_b64_tr_b16 a[162:163], v8 offset:12288
    v_mfma_f32_16x16x32_bf16 v[64:67], a[84:87], a[4:7], v[64:67]
    ds_read_b64_tr_b16 a[132:133], v9 offset:0
    ds_read_b64_tr_b16 a[134:135], v9 offset:4096
    v_mfma_f32_16x16x32_bf16 v[64:67], a[88:91], a[8:11], v[64:67]
    ds_read_b64_tr_b16 a[164:165], v9 offset:8192
    ds_read_b64_tr_b16 a[166:167], v9 offset:12288
    v_mfma_f32_16x16x32_bf16 v[64:67], a[92:95], a[12:15], v[64:67]
    ds_read_b64_tr_b16 a[136:137], v8 offset:256
    ds_read_b64_tr_b16 a[138:139], v8 offset:4352
    v_mfma_f32_16x16x32_bf16 v[72:75], a[96:99], a[0:3], 0
    buffer_load_dwordx4 v2, s[16:19], s30 offen offset:1024 nt lds
    v_mfma_f32_16x16x32_bf16 v[72:75], a[100:103], a[4:7], v[72:75]
    ds_read_b64_tr_b16 a[168:169], v8 offset:8448
    ds_read_b64_tr_b16 a[170:171], v8 offset:12544
    v_mfma_f32_16x16x32_bf16 v[72:75], a[104:107], a[8:11], v[72:75]
    ds_read_b64_tr_b16 a[140:141], v9 offset:256
    ds_read_b64_tr_b16 a[142:143], v9 offset:4352
    v_mfma_f32_16x16x32_bf16 v[72:75], a[108:111], a[12:15], v[72:75]
    ds_read_b64_tr_b16 a[172:173], v9 offset:8448
    ds_read_b64_tr_b16 a[174:175], v9 offset:12544
    v_mfma_f32_16x16x32_bf16 v[76:79], a[112:115], a[0:3], 0
    ds_read_b64_tr_b16 a[144:145], v8 offset:512
    ds_read_b64_tr_b16 a[146:147], v8 offset:4608
    v_mfma_f32_16x16x32_bf16 v[76:79], a[116:119], a[4:7], v[76:79]
    ds_read_b64_tr_b16 a[176:177], v8 offset:8704
    ds_read_b64_tr_b16 a[178:179], v8 offset:12800
    v_mfma_f32_16x16x32_bf16 v[76:79], a[120:123], a[8:11], v[76:79]
    buffer_load_dwordx4 v3, s[16:19], s30 offen offset:2048 nt lds
    v_mfma_f32_16x16x32_bf16 v[76:79], a[124:127], a[12:15], v[76:79]
    s_waitcnt lgkmcnt(12)
    ds_read_b64_tr_b16 a[148:149], v9 offset:512
    ds_read_b64_tr_b16 a[150:151], v9 offset:4608
    ds_read_b64_tr_b16 a[180:181], v9 offset:8704
    ds_read_b64_tr_b16 a[182:183], v9 offset:12800
    ds_read_b64_tr_b16 a[152:153], v8 offset:768
    ds_read_b64_tr_b16 a[154:155], v8 offset:4864
    ds_read_b64_tr_b16 a[184:185], v8 offset:8960
    s_waitcnt lgkmcnt(11)
    ds_read_b64_tr_b16 a[186:187], v8 offset:13056
    v_max3_f32 v26, v64, v65, v66
    v_max3_f32 v27, v67, v68, v69
    v_max3_f32 v26, v26, v70, v71
    v_max_f32 v26, v26, v27
    v_mov_b32 v27, v26
    s_nop 1
    v_permlane32_swap_b32 v26, v27
    v_max_f32 v26, v26, v27
    v_mov_b32 v27, v26
    s_nop 1
    v_permlane16_swap_b32 v26, v27
    v_min_f32_e64 v44, -v26, -v27
    v_pk_add_f32 v[64:65], v[64:65], v[44:45] op_sel_hi:[1,0]
    v_pk_add_f32 v[66:67], v[66:67], v[44:45] op_sel_hi:[1,0]
    v_pk_add_f32 v[68:69], v[68:69], v[44:45] op_sel_hi:[1,0]
    v_pk_add_f32 v[70:71], v[70:71], v[44:45] op_sel_hi:[1,0]
    v_exp_f32 v71, v71
    v_exp_f32 v70, v70
    v_exp_f32 v69, v69
    v_cvt_pk_bf16_f32 v71, v70, v71
    v_exp_f32 v68, v68
    v_exp_f32 v67, v67
    v_cvt_pk_bf16_f32 v70, v68, v69
    v_exp_f32 v66, v66
    v_exp_f32 v65, v65
    v_cvt_pk_bf16_f32 v69, v66, v67
    v_exp_f32 v64, v64
    s_nop 0
    v_cvt_pk_bf16_f32 v68, v64, v65
    buffer_load_dwordx4 v3, s[16:19], s30 offen offset:3072 nt lds
    v_pk_add_f32 v[72:73], v[72:73], v[44:45] op_sel_hi:[1,0]
    v_pk_add_f32 v[74:75], v[74:75], v[44:45] op_sel_hi:[1,0]
    v_pk_add_f32 v[76:77], v[76:77], v[44:45] op_sel_hi:[1,0]
    v_pk_add_f32 v[78:79], v[78:79], v[44:45] op_sel_hi:[1,0]
    v_exp_f32 v72, v72
    v_exp_f32 v73, v73
    v_exp_f32 v74, v74
    v_cvt_pk_bf16_f32 v72, v72, v73
    v_exp_f32 v75, v75
    v_exp_f32 v76, v76
    v_cvt_pk_bf16_f32 v73, v74, v75
    v_exp_f32 v77, v77
    v_exp_f32 v78, v78
    v_cvt_pk_bf16_f32 v74, v76, v77
    v_exp_f32 v79, v79
    s_nop 0
    v_cvt_pk_bf16_f32 v75, v78, v79
    ds_read_b64_tr_b16 a[156:157], v9 offset:768
    ds_read_b64_tr_b16 a[158:159], v9 offset:4864
    v_mfma_f32_16x16x32_bf16 v[128:131], a[128:131], v[68:71], 0
    ds_read_b64_tr_b16 a[188:189], v9 offset:8960
    ds_read_b64_tr_b16 a[190:191], v9 offset:13056
    v_mfma_f32_16x16x32_bf16 v[128:131], a[160:163], v[72:75], v[128:131]
    v_mov_b32 v45, v44
    v_mov_b32 v46, v44
    v_smfmac_f32_16x16x64_bf16 a[228:231], a[224:227], v[68:75], v4
    v_mov_b32 v47, v44
    v_mfma_f32_16x16x32_bf16 v[132:135], a[132:135], v[68:71], 0
    s_waitcnt lgkmcnt(8)
    v_mfma_f32_16x16x32_bf16 v[132:135], a[164:167], v[72:75], v[132:135]
    v_mfma_f32_16x16x32_bf16 v[136:139], a[136:139], v[68:71], 0
    s_mov_b32 m0, s61
    s_nop 0
    buffer_load_dwordx4 v2, s[16:19], s31 offen offset:0 nt lds
    v_mfma_f32_16x16x32_bf16 v[136:139], a[168:171], v[72:75], v[136:139]
    v_mfma_f32_16x16x32_bf16 v[140:143], a[140:143], v[68:71], 0
    v_mfma_f32_16x16x32_bf16 v[140:143], a[172:175], v[72:75], v[140:143]
    s_waitcnt lgkmcnt(0)
    v_mfma_f32_16x16x32_bf16 v[144:147], a[144:147], v[68:71], 0
    v_mfma_f32_16x16x32_bf16 v[144:147], a[176:179], v[72:75], v[144:147]
    v_mfma_f32_16x16x32_bf16 v[148:151], a[148:151], v[68:71], 0
    buffer_load_dwordx4 v2, s[16:19], s31 offen offset:1024 nt lds
    v_mfma_f32_16x16x32_bf16 v[148:151], a[180:183], v[72:75], v[148:151]
    v_mfma_f32_16x16x32_bf16 v[152:155], a[152:155], v[68:71], 0
    v_mfma_f32_16x16x32_bf16 v[152:155], a[184:187], v[72:75], v[152:155]
    v_mfma_f32_16x16x32_bf16 v[156:159], a[156:159], v[68:71], 0
    v_mfma_f32_16x16x32_bf16 v[156:159], a[188:191], v[72:75], v[156:159]
    s_waitcnt vmcnt(6)
    ds_read_b64 a[16:17], v13 offset:4096
    ds_read_b64 a[18:19], v13 offset:4096
    ds_read_b64 a[216:217], v13 offset:4104
    ds_read_b64 a[218:219], v13 offset:4104
    ds_read_b64 a[20:21], v13 offset:4352
    ds_read_b64 a[22:23], v13 offset:4352
    ds_read_b64 a[220:221], v13 offset:4360
    ds_read_b64 a[222:223], v13 offset:4360
    ds_read_b64 a[24:25], v13 offset:4608
    ds_read_b64 a[26:27], v13 offset:4608
    ds_read_b64 a[248:249], v13 offset:4616
    ds_read_b64 a[250:251], v13 offset:4616
    ds_read_b64 a[28:29], v13 offset:4864
    ds_read_b64 a[30:31], v13 offset:4864
    ds_read_b64 a[252:253], v13 offset:4872
    ds_read_b64 a[254:255], v13 offset:4872
    s_waitcnt lgkmcnt(14)
    v_mfma_f32_16x16x32_bf16 v[28:31], a[244:247], a[16:19], 0
    s_waitcnt lgkmcnt(12)
    v_mfma_f32_16x16x32_bf16 v[32:35], a[244:247], a[216:219], 0
    s_waitcnt lgkmcnt(10)
    v_mfma_f32_16x16x32_bf16 v[36:39], a[244:247], a[20:23], 0
    s_waitcnt lgkmcnt(8)
    v_mfma_f32_16x16x32_bf16 v[40:43], a[244:247], a[220:223], 0
    v_cvt_pk_bf16_f32 v28, v28, v29
    v_cvt_pk_bf16_f32 v29, v30, v31
    v_accvgpr_write_b32 a16, v28
    v_accvgpr_write_b32 a17, v29
    s_waitcnt lgkmcnt(6)
    v_mfma_f32_16x16x32_bf16 v[28:31], a[244:247], a[24:27], 0
    v_cvt_pk_bf16_f32 v32, v32, v33
    v_cvt_pk_bf16_f32 v33, v34, v35
    v_accvgpr_write_b32 a18, v32
    v_accvgpr_write_b32 a19, v33
    s_waitcnt lgkmcnt(4)
    v_mfma_f32_16x16x32_bf16 v[32:35], a[244:247], a[248:251], 0
    v_cvt_pk_bf16_f32 v36, v36, v37
    v_cvt_pk_bf16_f32 v37, v38, v39
    v_accvgpr_write_b32 a20, v36
    v_accvgpr_write_b32 a21, v37
    s_waitcnt lgkmcnt(2)
    v_mfma_f32_16x16x32_bf16 v[36:39], a[244:247], a[28:31], 0
    v_cvt_pk_bf16_f32 v40, v40, v41
    v_cvt_pk_bf16_f32 v41, v42, v43
    v_accvgpr_write_b32 a22, v40
    v_accvgpr_write_b32 a23, v41
    s_waitcnt lgkmcnt(0)
    v_mfma_f32_16x16x32_bf16 v[40:43], a[244:247], a[252:255], 0
    v_cvt_pk_bf16_f32 v28, v28, v29
    v_cvt_pk_bf16_f32 v29, v30, v31
    v_mfma_f32_16x16x32_bf16 v[84:87], a[64:67], a[16:19], 0
    v_cvt_pk_bf16_f32 v32, v32, v33
    v_cvt_pk_bf16_f32 v33, v34, v35
    v_mfma_f32_16x16x32_bf16 v[84:87], a[68:71], a[20:23], v[84:87]
    v_accvgpr_write_b32 a24, v28
    v_accvgpr_write_b32 a26, v32
    v_accvgpr_write_b32 a25, v29
    v_accvgpr_write_b32 a27, v33
    s_nop 1
    v_mfma_f32_16x16x32_bf16 v[84:87], a[72:75], a[24:27], v[84:87]
    buffer_load_dwordx4 v3, s[16:19], s31 offen offset:2048 nt lds
    v_cvt_pk_bf16_f32 v36, v36, v37
    v_cvt_pk_bf16_f32 v40, v40, v41
    v_cvt_pk_bf16_f32 v37, v38, v39
    v_cvt_pk_bf16_f32 v41, v42, v43
    v_accvgpr_write_b32 a28, v36
    v_accvgpr_write_b32 a30, v40
    v_accvgpr_write_b32 a29, v37
    v_accvgpr_write_b32 a31, v41
    s_nop 1
    v_mfma_f32_16x16x32_bf16 v[84:87], a[76:79], a[28:31], v[84:87]
    v_mfma_f32_16x16x32_bf16 v[80:83], a[80:83], a[16:19], 0
    v_mfma_f32_16x16x32_bf16 v[80:83], a[84:87], a[20:23], v[80:83]
    v_mfma_f32_16x16x32_bf16 v[80:83], a[88:91], a[24:27], v[80:83]
    buffer_load_dwordx4 v3, s[16:19], s31 offen offset:3072 nt lds
    v_mfma_f32_16x16x32_bf16 v[80:83], a[92:95], a[28:31], v[80:83]
    v_mfma_f32_16x16x32_bf16 v[88:91], a[96:99], a[16:19], 0
    v_mfma_f32_16x16x32_bf16 v[88:91], a[100:103], a[20:23], v[88:91]
    v_mfma_f32_16x16x32_bf16 v[88:91], a[104:107], a[24:27], v[88:91]
    v_max3_f32 v24, v80, v81, v82
    v_max3_f32 v25, v83, v84, v85
    v_mfma_f32_16x16x32_bf16 v[88:91], a[108:111], a[28:31], v[88:91]
    s_add_u32 s16, s4, s47
    s_addc_u32 s17, s5, 0
    s_mov_b32 s18, s51
    s_add_u32 s38, s35, 16384
    s_add_u32 m0, s26, s32
    s_nop 0
    buffer_load_dwordx4 v2, s[8:11], s38 offen offset:0 nt lds
    v_mfma_f32_16x16x32_bf16 v[92:95], a[112:115], a[16:19], 0
    v_max3_f32 v24, v24, v86, v87
    v_max_f32 v24, v24, v25
    v_mfma_f32_16x16x32_bf16 v[92:95], a[116:119], a[20:23], v[92:95]
    v_mov_b32 v25, v24
    v_mfma_f32_16x16x32_bf16 v[92:95], a[120:123], a[24:27], v[92:95]
    v_mfma_f32_16x16x32_bf16 v[92:95], a[124:127], a[28:31], v[92:95]
    buffer_load_dwordx4 v2, s[8:11], s38 offen offset:1024 nt lds
    v_permlane32_swap_b32 v24, v25
    v_max_f32 v24, v24, v25
    v_mov_b32 v25, v24
    s_nop 1
    v_permlane16_swap_b32 v24, v25
    v_min_f32_e64 v48, -v24, -v25
    v_pk_add_f32 v[80:81], v[80:81], v[48:49] op_sel_hi:[1,0]
    v_pk_add_f32 v[82:83], v[82:83], v[48:49] op_sel_hi:[1,0]
    v_pk_add_f32 v[84:85], v[84:85], v[48:49] op_sel_hi:[1,0]
    v_pk_add_f32 v[86:87], v[86:87], v[48:49] op_sel_hi:[1,0]
    v_exp_f32 v87, v87
    v_exp_f32 v86, v86
    v_exp_f32 v85, v85
    v_cvt_pk_bf16_f32 v87, v86, v87
    v_exp_f32 v84, v84
    v_exp_f32 v83, v83
    v_cvt_pk_bf16_f32 v86, v84, v85
    v_exp_f32 v82, v82
    v_exp_f32 v81, v81
    v_cvt_pk_bf16_f32 v85, v82, v83
    v_exp_f32 v80, v80
    s_nop 0
    v_cvt_pk_bf16_f32 v84, v80, v81
    buffer_load_dwordx4 v3, s[8:11], s38 offen offset:2048 nt lds
    v_pk_add_f32 v[88:89], v[88:89], v[48:49] op_sel_hi:[1,0]
    v_pk_add_f32 v[90:91], v[90:91], v[48:49] op_sel_hi:[1,0]
    v_pk_add_f32 v[92:93], v[92:93], v[48:49] op_sel_hi:[1,0]
    v_pk_add_f32 v[94:95], v[94:95], v[48:49] op_sel_hi:[1,0]
    v_exp_f32 v88, v88
    v_exp_f32 v89, v89
    v_exp_f32 v90, v90
    v_cvt_pk_bf16_f32 v88, v88, v89
    v_exp_f32 v91, v91
    v_exp_f32 v92, v92
    v_cvt_pk_bf16_f32 v89, v90, v91
    v_exp_f32 v93, v93
    v_exp_f32 v94, v94
    v_cvt_pk_bf16_f32 v90, v92, v93
    v_exp_f32 v95, v95
    s_nop 0
    v_cvt_pk_bf16_f32 v91, v94, v95
    v_mfma_f32_16x16x32_bf16 v[160:163], a[128:131], v[84:87], 0
    v_mov_b32 v49, v48
    v_mov_b32 v50, v48
    v_mfma_f32_16x16x32_bf16 v[160:163], a[160:163], v[88:91], v[160:163]
    v_mov_b32 v51, v48
    v_smfmac_f32_16x16x64_bf16 a[232:235], a[224:227], v[84:91], v4
    v_mfma_f32_16x16x32_bf16 v[164:167], a[132:135], v[84:87], 0
    buffer_load_dwordx4 v3, s[8:11], s38 offen offset:3072 nt lds
    v_mfma_f32_16x16x32_bf16 v[164:167], a[164:167], v[88:91], v[164:167]
    v_mfma_f32_16x16x32_bf16 v[168:171], a[136:139], v[84:87], 0
    v_mfma_f32_16x16x32_bf16 v[168:171], a[168:171], v[88:91], v[168:171]
    v_mfma_f32_16x16x32_bf16 v[172:175], a[140:143], v[84:87], 0
    v_mfma_f32_16x16x32_bf16 v[172:175], a[172:175], v[88:91], v[172:175]
    s_add_u32 m0, s26, s33
    s_nop 0
    buffer_load_dwordx4 v2, s[12:15], s38 offen offset:0 nt lds
    v_mfma_f32_16x16x32_bf16 v[176:179], a[144:147], v[84:87], 0
    v_mfma_f32_16x16x32_bf16 v[176:179], a[176:179], v[88:91], v[176:179]
    v_mfma_f32_16x16x32_bf16 v[180:183], a[148:151], v[84:87], 0
    v_mfma_f32_16x16x32_bf16 v[180:183], a[180:183], v[88:91], v[180:183]
    buffer_load_dwordx4 v3, s[12:15], s38 offen offset:1024 nt lds
    v_mfma_f32_16x16x32_bf16 v[184:187], a[152:155], v[84:87], 0
    v_mfma_f32_16x16x32_bf16 v[184:187], a[184:187], v[88:91], v[184:187]
    v_mfma_f32_16x16x32_bf16 v[188:191], a[156:159], v[84:87], 0
    v_mfma_f32_16x16x32_bf16 v[188:191], a[188:191], v[88:91], v[188:191]
    s_waitcnt vmcnt(10)
    ds_read_b64 a[32:33], v13 offset:8192
    ds_read_b64 a[34:35], v13 offset:8192
    ds_read_b64 a[216:217], v13 offset:8200
    ds_read_b64 a[218:219], v13 offset:8200
    ds_read_b64 a[36:37], v13 offset:8448
    ds_read_b64 a[38:39], v13 offset:8448
    ds_read_b64 a[220:221], v13 offset:8456
    ds_read_b64 a[222:223], v13 offset:8456
    ds_read_b64 a[40:41], v13 offset:8704
    ds_read_b64 a[42:43], v13 offset:8704
    ds_read_b64 a[248:249], v13 offset:8712
    ds_read_b64 a[250:251], v13 offset:8712
    ds_read_b64 a[44:45], v13 offset:8960
    ds_read_b64 a[46:47], v13 offset:8960
    ds_read_b64 a[252:253], v13 offset:8968
    ds_read_b64 a[254:255], v13 offset:8968
    s_waitcnt lgkmcnt(14)
    v_mfma_f32_16x16x32_bf16 v[28:31], a[244:247], a[32:35], 0
    s_waitcnt lgkmcnt(12)
    v_mfma_f32_16x16x32_bf16 v[32:35], a[244:247], a[216:219], 0
    s_waitcnt lgkmcnt(10)
    v_mfma_f32_16x16x32_bf16 v[36:39], a[244:247], a[36:39], 0
    s_waitcnt lgkmcnt(8)
    v_mfma_f32_16x16x32_bf16 v[40:43], a[244:247], a[220:223], 0
    v_cvt_pk_bf16_f32 v28, v28, v29
    v_cvt_pk_bf16_f32 v29, v30, v31
    v_accvgpr_write_b32 a32, v28
    v_accvgpr_write_b32 a33, v29
    s_waitcnt lgkmcnt(6)
    v_mfma_f32_16x16x32_bf16 v[28:31], a[244:247], a[40:43], 0
    v_cvt_pk_bf16_f32 v32, v32, v33
    v_cvt_pk_bf16_f32 v33, v34, v35
    v_accvgpr_write_b32 a34, v32
    v_accvgpr_write_b32 a35, v33
    s_waitcnt lgkmcnt(4)
    v_mfma_f32_16x16x32_bf16 v[32:35], a[244:247], a[248:251], 0
    v_cvt_pk_bf16_f32 v36, v36, v37
    v_cvt_pk_bf16_f32 v37, v38, v39
    v_accvgpr_write_b32 a36, v36
    v_accvgpr_write_b32 a37, v37
    s_waitcnt lgkmcnt(2)
    v_mfma_f32_16x16x32_bf16 v[36:39], a[244:247], a[44:47], 0
    v_cvt_pk_bf16_f32 v40, v40, v41
    v_cvt_pk_bf16_f32 v41, v42, v43
    v_accvgpr_write_b32 a38, v40
    v_accvgpr_write_b32 a39, v41
    s_waitcnt lgkmcnt(0)
    v_mfma_f32_16x16x32_bf16 v[40:43], a[244:247], a[252:255], 0
    v_cvt_pk_bf16_f32 v28, v28, v29
    v_cvt_pk_bf16_f32 v29, v30, v31
    v_mfma_f32_16x16x32_bf16 v[100:103], a[64:67], a[32:35], 0
    v_cvt_pk_bf16_f32 v32, v32, v33
    v_cvt_pk_bf16_f32 v33, v34, v35
    v_mfma_f32_16x16x32_bf16 v[100:103], a[68:71], a[36:39], v[100:103]
    v_accvgpr_write_b32 a40, v28
    v_accvgpr_write_b32 a42, v32
    v_accvgpr_write_b32 a41, v29
    v_accvgpr_write_b32 a43, v33
    s_nop 1
    v_mfma_f32_16x16x32_bf16 v[100:103], a[72:75], a[40:43], v[100:103]
    buffer_load_dwordx4 v2, s[12:15], s38 offen offset:2048 nt lds
    v_cvt_pk_bf16_f32 v36, v36, v37
    v_cvt_pk_bf16_f32 v40, v40, v41
    v_cvt_pk_bf16_f32 v37, v38, v39
    v_cvt_pk_bf16_f32 v41, v42, v43
    v_accvgpr_write_b32 a44, v36
    v_accvgpr_write_b32 a46, v40
    v_accvgpr_write_b32 a45, v37
    v_accvgpr_write_b32 a47, v41
    s_nop 1
    v_mfma_f32_16x16x32_bf16 v[100:103], a[76:79], a[44:47], v[100:103]
    v_mfma_f32_16x16x32_bf16 v[96:99], a[80:83], a[32:35], 0
    v_mfma_f32_16x16x32_bf16 v[96:99], a[84:87], a[36:39], v[96:99]
    v_mfma_f32_16x16x32_bf16 v[96:99], a[88:91], a[40:43], v[96:99]
    buffer_load_dwordx4 v3, s[12:15], s38 offen offset:3072 nt lds
    v_mfma_f32_16x16x32_bf16 v[96:99], a[92:95], a[44:47], v[96:99]
    v_mfma_f32_16x16x32_bf16 v[104:107], a[96:99], a[32:35], 0
    v_mfma_f32_16x16x32_bf16 v[104:107], a[100:103], a[36:39], v[104:107]
    v_mfma_f32_16x16x32_bf16 v[104:107], a[104:107], a[40:43], v[104:107]
    v_max3_f32 v26, v96, v97, v98
    v_max3_f32 v27, v99, v100, v101
    v_mfma_f32_16x16x32_bf16 v[104:107], a[108:111], a[44:47], v[104:107]
    s_add_u32 s38, s35, 32768
    s_add_u32 m0, s27, s32
    s_nop 0
    buffer_load_dwordx4 v2, s[8:11], s38 offen offset:0 nt lds
    v_mfma_f32_16x16x32_bf16 v[108:111], a[112:115], a[32:35], 0
    v_max3_f32 v26, v26, v102, v103
    v_max_f32 v26, v26, v27
    v_mfma_f32_16x16x32_bf16 v[108:111], a[116:119], a[36:39], v[108:111]
    v_mov_b32 v27, v26
    v_mfma_f32_16x16x32_bf16 v[108:111], a[120:123], a[40:43], v[108:111]
    v_mfma_f32_16x16x32_bf16 v[108:111], a[124:127], a[44:47], v[108:111]
    buffer_load_dwordx4 v2, s[8:11], s38 offen offset:1024 nt lds
    v_permlane32_swap_b32 v26, v27
    v_max_f32 v26, v26, v27
    v_mov_b32 v27, v26
    s_nop 1
    v_permlane16_swap_b32 v26, v27
    v_min_f32_e64 v52, -v26, -v27
    v_pk_add_f32 v[96:97], v[96:97], v[52:53] op_sel_hi:[1,0]
    v_pk_add_f32 v[98:99], v[98:99], v[52:53] op_sel_hi:[1,0]
    v_pk_add_f32 v[100:101], v[100:101], v[52:53] op_sel_hi:[1,0]
    v_pk_add_f32 v[102:103], v[102:103], v[52:53] op_sel_hi:[1,0]
    v_exp_f32 v103, v103
    v_exp_f32 v102, v102
    v_exp_f32 v101, v101
    v_cvt_pk_bf16_f32 v103, v102, v103
    v_exp_f32 v100, v100
    v_exp_f32 v99, v99
    v_cvt_pk_bf16_f32 v102, v100, v101
    v_exp_f32 v98, v98
    v_exp_f32 v97, v97
    v_cvt_pk_bf16_f32 v101, v98, v99
    v_exp_f32 v96, v96
    s_nop 0
    v_cvt_pk_bf16_f32 v100, v96, v97
    buffer_load_dwordx4 v3, s[8:11], s38 offen offset:2048 nt lds
    v_pk_add_f32 v[104:105], v[104:105], v[52:53] op_sel_hi:[1,0]
    v_pk_add_f32 v[106:107], v[106:107], v[52:53] op_sel_hi:[1,0]
    v_pk_add_f32 v[108:109], v[108:109], v[52:53] op_sel_hi:[1,0]
    v_pk_add_f32 v[110:111], v[110:111], v[52:53] op_sel_hi:[1,0]
    v_exp_f32 v104, v104
    v_exp_f32 v105, v105
    v_exp_f32 v106, v106
    v_cvt_pk_bf16_f32 v104, v104, v105
    v_exp_f32 v107, v107
    v_exp_f32 v108, v108
    v_cvt_pk_bf16_f32 v105, v106, v107
    v_exp_f32 v109, v109
    v_exp_f32 v110, v110
    v_cvt_pk_bf16_f32 v106, v108, v109
    v_exp_f32 v111, v111
    s_nop 0
    v_cvt_pk_bf16_f32 v107, v110, v111
    v_mfma_f32_16x16x32_bf16 v[192:195], a[128:131], v[100:103], 0
    v_mov_b32 v53, v52
    v_mov_b32 v54, v52
    v_mfma_f32_16x16x32_bf16 v[192:195], a[160:163], v[104:107], v[192:195]
    v_mov_b32 v55, v52
    v_smfmac_f32_16x16x64_bf16 a[236:239], a[224:227], v[100:107], v4
    v_mfma_f32_16x16x32_bf16 v[196:199], a[132:135], v[100:103], 0
    buffer_load_dwordx4 v3, s[8:11], s38 offen offset:3072 nt lds
    v_mfma_f32_16x16x32_bf16 v[196:199], a[164:167], v[104:107], v[196:199]
    v_mfma_f32_16x16x32_bf16 v[200:203], a[136:139], v[100:103], 0
    v_mfma_f32_16x16x32_bf16 v[200:203], a[168:171], v[104:107], v[200:203]
    v_mfma_f32_16x16x32_bf16 v[204:207], a[140:143], v[100:103], 0
    v_mfma_f32_16x16x32_bf16 v[204:207], a[172:175], v[104:107], v[204:207]
    s_add_u32 m0, s27, s33
    s_nop 0
    buffer_load_dwordx4 v2, s[12:15], s38 offen offset:0 nt lds
    v_mfma_f32_16x16x32_bf16 v[208:211], a[144:147], v[100:103], 0
    v_mfma_f32_16x16x32_bf16 v[208:211], a[176:179], v[104:107], v[208:211]
    v_mfma_f32_16x16x32_bf16 v[212:215], a[148:151], v[100:103], 0
    v_mfma_f32_16x16x32_bf16 v[212:215], a[180:183], v[104:107], v[212:215]
    buffer_load_dwordx4 v3, s[12:15], s38 offen offset:1024 nt lds
    v_mfma_f32_16x16x32_bf16 v[216:219], a[152:155], v[100:103], 0
    v_mfma_f32_16x16x32_bf16 v[216:219], a[184:187], v[104:107], v[216:219]
    v_mfma_f32_16x16x32_bf16 v[220:223], a[156:159], v[100:103], 0
    v_mfma_f32_16x16x32_bf16 v[220:223], a[188:191], v[104:107], v[220:223]
    s_waitcnt vmcnt(14)
    ds_read_b64 a[48:49], v13 offset:12288
    ds_read_b64 a[50:51], v13 offset:12288
    ds_read_b64 a[216:217], v13 offset:12296
    ds_read_b64 a[218:219], v13 offset:12296
    ds_read_b64 a[52:53], v13 offset:12544
    ds_read_b64 a[54:55], v13 offset:12544
    ds_read_b64 a[220:221], v13 offset:12552
    ds_read_b64 a[222:223], v13 offset:12552
    ds_read_b64 a[56:57], v13 offset:12800
    ds_read_b64 a[58:59], v13 offset:12800
    ds_read_b64 a[248:249], v13 offset:12808
    ds_read_b64 a[250:251], v13 offset:12808
    ds_read_b64 a[60:61], v13 offset:13056
    ds_read_b64 a[62:63], v13 offset:13056
    ds_read_b64 a[252:253], v13 offset:13064
    ds_read_b64 a[254:255], v13 offset:13064
    s_waitcnt lgkmcnt(14)
    v_mfma_f32_16x16x32_bf16 v[28:31], a[244:247], a[48:51], 0
    s_waitcnt lgkmcnt(12)
    v_mfma_f32_16x16x32_bf16 v[32:35], a[244:247], a[216:219], 0
    s_waitcnt lgkmcnt(10)
    v_mfma_f32_16x16x32_bf16 v[36:39], a[244:247], a[52:55], 0
    s_waitcnt lgkmcnt(8)
    v_mfma_f32_16x16x32_bf16 v[40:43], a[244:247], a[220:223], 0
    v_cvt_pk_bf16_f32 v28, v28, v29
    v_cvt_pk_bf16_f32 v29, v30, v31
    v_accvgpr_write_b32 a48, v28
    v_accvgpr_write_b32 a49, v29
    s_waitcnt lgkmcnt(6)
    v_mfma_f32_16x16x32_bf16 v[28:31], a[244:247], a[56:59], 0
    v_cvt_pk_bf16_f32 v32, v32, v33
    v_cvt_pk_bf16_f32 v33, v34, v35
    v_accvgpr_write_b32 a50, v32
    v_accvgpr_write_b32 a51, v33
    s_waitcnt lgkmcnt(4)
    v_mfma_f32_16x16x32_bf16 v[32:35], a[244:247], a[248:251], 0
    v_cvt_pk_bf16_f32 v36, v36, v37
    v_cvt_pk_bf16_f32 v37, v38, v39
    v_accvgpr_write_b32 a52, v36
    v_accvgpr_write_b32 a53, v37
    s_waitcnt lgkmcnt(2)
    v_mfma_f32_16x16x32_bf16 v[36:39], a[244:247], a[60:63], 0
    v_cvt_pk_bf16_f32 v40, v40, v41
    v_cvt_pk_bf16_f32 v41, v42, v43
    v_accvgpr_write_b32 a54, v40
    v_accvgpr_write_b32 a55, v41
    s_waitcnt lgkmcnt(0)
    v_mfma_f32_16x16x32_bf16 v[40:43], a[244:247], a[252:255], 0
    s_waitcnt vmcnt(10)
    s_barrier
    v_mfma_f32_16x16x32_bf16 v[116:119], a[64:67], a[48:51], 0
    ds_read_b128 a[64:67], v10 offset:4096
    v_cvt_pk_bf16_f32 v28, v28, v29
    v_mfma_f32_16x16x32_bf16 v[116:119], a[68:71], a[52:55], v[116:119]
    ds_read_b128 a[68:71], v10 offset:4352
    v_cvt_pk_bf16_f32 v32, v32, v33
    v_cvt_pk_bf16_f32 v29, v30, v31
    v_cvt_pk_bf16_f32 v33, v34, v35
    v_accvgpr_write_b32 a56, v28
    v_accvgpr_write_b32 a58, v32
    v_accvgpr_write_b32 a57, v29
    v_accvgpr_write_b32 a59, v33
    s_nop 1
    v_mfma_f32_16x16x32_bf16 v[116:119], a[72:75], a[56:59], v[116:119]
    ds_read_b128 a[72:75], v10 offset:4608
    v_cvt_pk_bf16_f32 v36, v36, v37
    v_cvt_pk_bf16_f32 v40, v40, v41
    v_cvt_pk_bf16_f32 v37, v38, v39
    v_cvt_pk_bf16_f32 v41, v42, v43
    v_accvgpr_write_b32 a60, v36
    v_accvgpr_write_b32 a62, v40
    v_accvgpr_write_b32 a61, v37
    v_accvgpr_write_b32 a63, v41
    s_nop 1
    v_mfma_f32_16x16x32_bf16 v[116:119], a[76:79], a[60:63], v[116:119]
    ds_read_b128 a[76:79], v10 offset:4864
    v_mfma_f32_16x16x32_bf16 v[112:115], a[80:83], a[48:51], 0
    ds_read_b128 a[80:83], v10 offset:0
    v_mfma_f32_16x16x32_bf16 v[112:115], a[84:87], a[52:55], v[112:115]
    ds_read_b128 a[84:87], v10 offset:256
    v_mfma_f32_16x16x32_bf16 v[112:115], a[88:91], a[56:59], v[112:115]
    ds_read_b128 a[88:91], v10 offset:512
    v_mfma_f32_16x16x32_bf16 v[112:115], a[92:95], a[60:63], v[112:115]
    ds_read_b128 a[92:95], v10 offset:768
    v_mfma_f32_16x16x32_bf16 v[120:123], a[96:99], a[48:51], 0
    ds_read_b128 a[96:99], v10 offset:8192
    v_mfma_f32_16x16x32_bf16 v[120:123], a[100:103], a[52:55], v[120:123]
    ds_read_b128 a[100:103], v10 offset:8448
    v_mfma_f32_16x16x32_bf16 v[120:123], a[104:107], a[56:59], v[120:123]
    ds_read_b128 a[104:107], v10 offset:8704
    v_max3_f32 v24, v112, v113, v114
    v_mfma_f32_16x16x32_bf16 v[120:123], a[108:111], a[60:63], v[120:123]
    ds_read_b128 a[108:111], v10 offset:8960
    v_max3_f32 v25, v115, v116, v117
    v_mfma_f32_16x16x32_bf16 v[124:127], a[112:115], a[48:51], 0
    ds_read_b128 a[112:115], v10 offset:12288
    v_max3_f32 v24, v24, v118, v119
    v_mfma_f32_16x16x32_bf16 v[124:127], a[116:119], a[52:55], v[124:127]
    ds_read_b128 a[116:119], v10 offset:12544
    v_max_f32 v24, v24, v25
    v_mfma_f32_16x16x32_bf16 v[124:127], a[120:123], a[56:59], v[124:127]
    ds_read_b128 a[120:123], v10 offset:12800
    v_mov_b32 v25, v24
    v_mfma_f32_16x16x32_bf16 v[124:127], a[124:127], a[60:63], v[124:127]
    s_waitcnt lgkmcnt(7)
    ds_read_b128 a[124:127], v10 offset:13056
    v_mfma_f32_16x16x32_bf16 v[68:71], a[64:67], a[0:3], v[44:47]
    v_permlane32_swap_b32 v24, v25
    v_mfma_f32_16x16x32_bf16 v[68:71], a[68:71], a[4:7], v[68:71]
    v_max_f32 v24, v24, v25
    v_mov_b32 v25, v24
    v_mfma_f32_16x16x32_bf16 v[68:71], a[72:75], a[8:11], v[68:71]
    buffer_load_dwordx4 v2, s[12:15], s38 offen offset:2048 nt lds
    v_mfma_f32_16x16x32_bf16 v[68:71], a[76:79], a[12:15], v[68:71]
    v_permlane16_swap_b32 v24, v25
    v_mfma_f32_16x16x32_bf16 v[64:67], a[80:83], a[0:3], v[44:47]
    v_min_f32_e64 v56, -v24, -v25
    v_mov_b32 v57, v56
    v_mov_b32 v58, v56
    v_mov_b32 v59, v56
    v_mfma_f32_16x16x32_bf16 v[64:67], a[84:87], a[4:7], v[64:67]
    v_mfma_f32_16x16x32_bf16 v[64:67], a[88:91], a[8:11], v[64:67]
    v_exp_f32 v71, v71
    v_exp_f32 v70, v70
    v_exp_f32 v69, v69
    v_pk_add_f32 v[112:113], v[112:113], v[56:57] op_sel_hi:[1,0]
    v_pk_add_f32 v[114:115], v[114:115], v[56:57] op_sel_hi:[1,0]
    v_pk_add_f32 v[116:117], v[116:117], v[56:57] op_sel_hi:[1,0]
    v_pk_add_f32 v[118:119], v[118:119], v[56:57] op_sel_hi:[1,0]
    v_pk_add_f32 v[120:121], v[120:121], v[56:57] op_sel_hi:[1,0]
    v_pk_add_f32 v[122:123], v[122:123], v[56:57] op_sel_hi:[1,0]
    v_pk_add_f32 v[124:125], v[124:125], v[56:57] op_sel_hi:[1,0]
    v_pk_add_f32 v[126:127], v[126:127], v[56:57] op_sel_hi:[1,0]
    v_mfma_f32_16x16x32_bf16 v[64:67], a[92:95], a[12:15], v[64:67]
    s_waitcnt lgkmcnt(0)
    v_exp_f32 v119, v119
    v_mfma_f32_16x16x32_bf16 v[72:75], a[96:99], a[0:3], v[44:47]
    v_exp_f32 v118, v118
    v_mfma_f32_16x16x32_bf16 v[72:75], a[100:103], a[4:7], v[72:75]
    v_exp_f32 v117, v117
    v_mfma_f32_16x16x32_bf16 v[72:75], a[104:107], a[8:11], v[72:75]
    v_exp_f32 v116, v116
    v_mfma_f32_16x16x32_bf16 v[72:75], a[108:111], a[12:15], v[72:75]
    v_exp_f32 v115, v115
    v_mfma_f32_16x16x32_bf16 v[76:79], a[112:115], a[0:3], v[44:47]
    v_exp_f32 v114, v114
    v_mfma_f32_16x16x32_bf16 v[76:79], a[116:119], a[4:7], v[76:79]
    v_exp_f32 v113, v113
    v_cvt_pk_bf16_f32 v119, v118, v119
    v_cvt_pk_bf16_f32 v118, v116, v117
    v_cvt_pk_bf16_f32 v117, v114, v115
    v_exp_f32 v112, v112
    s_nop 0
    v_cvt_pk_bf16_f32 v116, v112, v113
    v_mfma_f32_16x16x32_bf16 v[76:79], a[120:123], a[8:11], v[76:79]
    buffer_load_dwordx4 v3, s[12:15], s38 offen offset:3072 nt lds
    v_exp_f32 v120, v120
    v_exp_f32 v121, v121
    v_exp_f32 v122, v122
    v_cvt_pk_bf16_f32 v120, v120, v121
    v_exp_f32 v123, v123
    v_exp_f32 v124, v124
    v_cvt_pk_bf16_f32 v121, v122, v123
    v_exp_f32 v125, v125
    v_exp_f32 v126, v126
    v_cvt_pk_bf16_f32 v122, v124, v125
    v_exp_f32 v127, v127
    s_nop 0
    v_cvt_pk_bf16_f32 v123, v126, v127
    v_mfma_f32_16x16x32_bf16 v[76:79], a[124:127], a[12:15], v[76:79]
    s_waitcnt vmcnt(8)
    s_barrier
    v_mfma_f32_16x16x32_bf16 v[224:227], a[128:131], v[116:119], 0
    ds_read_b64_tr_b16 a[128:129], v11 offset:0
    v_cvt_pk_bf16_f32 v71, v70, v71
    v_mfma_f32_16x16x32_bf16 v[224:227], a[160:163], v[120:123], v[224:227]
    ds_read_b64_tr_b16 a[130:131], v11 offset:4096
    v_exp_f32 v68, v68
    v_smfmac_f32_16x16x64_bf16 a[240:243], a[224:227], v[116:123], v4
    ds_read_b64_tr_b16 a[160:161], v11 offset:8192
    v_mfma_f32_16x16x32_bf16 v[228:231], a[132:135], v[116:119], 0
    ds_read_b64_tr_b16 a[162:163], v11 offset:12288
    v_cvt_pk_bf16_f32 v70, v68, v69
    v_mfma_f32_16x16x32_bf16 v[228:231], a[164:167], v[120:123], v[228:231]
    ds_read_b64_tr_b16 a[132:133], v12 offset:0
    v_exp_f32 v67, v67
    v_mfma_f32_16x16x32_bf16 v[232:235], a[136:139], v[116:119], 0
    ds_read_b64_tr_b16 a[134:135], v12 offset:4096
    v_exp_f32 v66, v66
    v_mfma_f32_16x16x32_bf16 v[232:235], a[168:171], v[120:123], v[232:235]
    ds_read_b64_tr_b16 a[164:165], v12 offset:8192
    v_cvt_pk_bf16_f32 v69, v66, v67
    v_mfma_f32_16x16x32_bf16 v[236:239], a[140:143], v[116:119], 0
    ds_read_b64_tr_b16 a[166:167], v12 offset:12288
    v_exp_f32 v65, v65
    v_mfma_f32_16x16x32_bf16 v[236:239], a[172:175], v[120:123], v[236:239]
    ds_read_b64_tr_b16 a[136:137], v11 offset:256
    v_exp_f32 v64, v64
    v_mfma_f32_16x16x32_bf16 v[240:243], a[144:147], v[116:119], 0
    ds_read_b64_tr_b16 a[138:139], v11 offset:4352
    v_cvt_pk_bf16_f32 v68, v64, v65
    v_mfma_f32_16x16x32_bf16 v[240:243], a[176:179], v[120:123], v[240:243]
    ds_read_b64_tr_b16 a[168:169], v11 offset:8448
    v_exp_f32 v72, v72
    v_mfma_f32_16x16x32_bf16 v[244:247], a[148:151], v[116:119], 0
    ds_read_b64_tr_b16 a[170:171], v11 offset:12544
    v_exp_f32 v73, v73
    v_mfma_f32_16x16x32_bf16 v[244:247], a[180:183], v[120:123], v[244:247]
    ds_read_b64_tr_b16 a[140:141], v12 offset:256
    v_cvt_pk_bf16_f32 v72, v72, v73
    v_mfma_f32_16x16x32_bf16 v[248:251], a[152:155], v[116:119], 0
    ds_read_b64_tr_b16 a[142:143], v12 offset:4352
    s_add_u32 s38, s35, 49152
    s_add_u32 m0, s25, s32
    v_mfma_f32_16x16x32_bf16 v[248:251], a[184:187], v[120:123], v[248:251]
    buffer_load_dwordx4 v2, s[8:11], s38 offen offset:0 nt lds
    v_mfma_f32_16x16x32_bf16 v[252:255], a[156:159], v[116:119], 0
    ds_read_b64_tr_b16 a[172:173], v12 offset:8448
    v_exp_f32 v74, v74
    v_mfma_f32_16x16x32_bf16 v[252:255], a[188:191], v[120:123], v[252:255]
    ds_read_b64_tr_b16 a[174:175], v12 offset:12544
    v_exp_f32 v75, v75
    v_mfma_f32_16x16x32_bf16 v[84:87], a[64:67], a[16:19], v[48:51]
    s_waitcnt lgkmcnt(8)
    v_exp_f32 v76, v76
    v_mfma_f32_16x16x32_bf16 v[84:87], a[68:71], a[20:23], v[84:87]
    ds_read_b64_tr_b16 a[144:145], v11 offset:512
    v_cvt_pk_bf16_f32 v73, v74, v75
    v_mfma_f32_16x16x32_bf16 v[84:87], a[72:75], a[24:27], v[84:87]
    buffer_load_dwordx4 v2, s[8:11], s38 offen offset:1024 nt lds
    v_mfma_f32_16x16x32_bf16 v[84:87], a[76:79], a[28:31], v[84:87]
    ds_read_b64_tr_b16 a[146:147], v11 offset:4608
    v_exp_f32 v77, v77
    v_mfma_f32_16x16x32_bf16 v[80:83], a[80:83], a[16:19], v[48:51]
    ds_read_b64_tr_b16 a[176:177], v11 offset:8704
    v_cvt_pk_bf16_f32 v74, v76, v77
    v_mfma_f32_16x16x32_bf16 v[80:83], a[84:87], a[20:23], v[80:83]
    ds_read_b64_tr_b16 a[178:179], v11 offset:12800
    v_exp_f32 v78, v78
    v_mfma_f32_16x16x32_bf16 v[80:83], a[88:91], a[24:27], v[80:83]
    ds_read_b64_tr_b16 a[148:149], v12 offset:512
    v_exp_f32 v79, v79
    v_mfma_f32_16x16x32_bf16 v[80:83], a[92:95], a[28:31], v[80:83]
    buffer_load_dwordx4 v3, s[8:11], s38 offen offset:2048 nt lds
    v_mfma_f32_16x16x32_bf16 v[88:91], a[96:99], a[16:19], v[48:51]
    ds_read_b64_tr_b16 a[150:151], v12 offset:4608
    v_cvt_pk_bf16_f32 v75, v78, v79
    v_mfma_f32_16x16x32_bf16 v[88:91], a[100:103], a[20:23], v[88:91]
    ds_read_b64_tr_b16 a[180:181], v12 offset:8704
    v_exp_f32 v87, v87
    v_mfma_f32_16x16x32_bf16 v[88:91], a[104:107], a[24:27], v[88:91]
    ds_read_b64_tr_b16 a[182:183], v12 offset:12800
    v_exp_f32 v86, v86
    v_mfma_f32_16x16x32_bf16 v[88:91], a[108:111], a[28:31], v[88:91]
    s_waitcnt lgkmcnt(8)
    v_exp_f32 v85, v85
    v_mfma_f32_16x16x32_bf16 v[92:95], a[112:115], a[16:19], v[48:51]
    buffer_load_dwordx4 v3, s[8:11], s38 offen offset:3072 nt lds
    v_mfma_f32_16x16x32_bf16 v[92:95], a[116:119], a[20:23], v[92:95]
    s_add_u32 m0, s25, s33
    v_exp_f32 v84, v84
    v_mfma_f32_16x16x32_bf16 v[92:95], a[120:123], a[24:27], v[92:95]
    ds_read_b64_tr_b16 a[152:153], v11 offset:768
    v_cvt_pk_bf16_f32 v87, v86, v87
    v_mfma_f32_16x16x32_bf16 v[92:95], a[124:127], a[28:31], v[92:95]
    ds_read_b64_tr_b16 a[154:155], v11 offset:4864
    v_cvt_pk_bf16_f32 v86, v84, v85
    v_mfma_f32_16x16x32_bf16 v[100:103], a[64:67], a[32:35], v[52:55]
    ds_read_b64_tr_b16 a[184:185], v11 offset:8960
    v_exp_f32 v83, v83
    v_mfma_f32_16x16x32_bf16 v[100:103], a[68:71], a[36:39], v[100:103]
    buffer_load_dwordx4 v2, s[12:15], s38 offen offset:0 nt lds
    v_mfma_f32_16x16x32_bf16 v[100:103], a[72:75], a[40:43], v[100:103]
    ds_read_b64_tr_b16 a[186:187], v11 offset:13056
    v_exp_f32 v82, v82
    v_mfma_f32_16x16x32_bf16 v[100:103], a[76:79], a[44:47], v[100:103]
    ds_read_b64_tr_b16 a[156:157], v12 offset:768
    v_cvt_pk_bf16_f32 v85, v82, v83
    v_mfma_f32_16x16x32_bf16 v[96:99], a[80:83], a[32:35], v[52:55]
    ds_read_b64_tr_b16 a[158:159], v12 offset:4864
    v_exp_f32 v81, v81
    v_mfma_f32_16x16x32_bf16 v[96:99], a[84:87], a[36:39], v[96:99]
    ds_read_b64_tr_b16 a[188:189], v12 offset:8960
    v_exp_f32 v80, v80
    v_mfma_f32_16x16x32_bf16 v[96:99], a[88:91], a[40:43], v[96:99]
    buffer_load_dwordx4 v3, s[12:15], s38 offen offset:1024 nt lds
    v_mfma_f32_16x16x32_bf16 v[96:99], a[92:95], a[44:47], v[96:99]
    ds_read_b64_tr_b16 a[190:191], v12 offset:13056
    v_cvt_pk_bf16_f32 v84, v80, v81
    v_mfma_f32_16x16x32_bf16 v[104:107], a[96:99], a[32:35], v[52:55]
    s_waitcnt lgkmcnt(8)
    v_exp_f32 v103, v103
    v_mfma_f32_16x16x32_bf16 v[104:107], a[100:103], a[36:39], v[104:107]
    v_exp_f32 v102, v102
    v_mfma_f32_16x16x32_bf16 v[104:107], a[104:107], a[40:43], v[104:107]
    v_exp_f32 v101, v101
    v_mfma_f32_16x16x32_bf16 v[104:107], a[108:111], a[44:47], v[104:107]
    buffer_load_dwordx4 v2, s[12:15], s38 offen offset:2048 nt lds
    v_mfma_f32_16x16x32_bf16 v[108:111], a[112:115], a[32:35], v[52:55]
    v_exp_f32 v100, v100
    v_mfma_f32_16x16x32_bf16 v[108:111], a[116:119], a[36:39], v[108:111]
    v_exp_f32 v99, v99
    v_mfma_f32_16x16x32_bf16 v[108:111], a[120:123], a[40:43], v[108:111]
    v_exp_f32 v98, v98
    v_mfma_f32_16x16x32_bf16 v[108:111], a[124:127], a[44:47], v[108:111]
    s_waitcnt lgkmcnt(0)
    v_exp_f32 v97, v97
    v_mfma_f32_16x16x32_bf16 v[128:131], a[128:131], v[68:71], v[128:131]
    buffer_load_dwordx4 v3, s[12:15], s38 offen offset:3072 nt lds
    v_mfma_f32_16x16x32_bf16 v[128:131], a[160:163], v[72:75], v[128:131]
    s_add_u32 s38, s35, 65536
    v_exp_f32 v96, v96
    v_smfmac_f32_16x16x64_bf16 a[228:231], a[224:227], v[68:75], v4
    s_add_u32 m0, s26, s32
    v_cvt_pk_bf16_f32 v103, v102, v103
    v_mfma_f32_16x16x32_bf16 v[132:135], a[132:135], v[68:71], v[132:135]
    v_exp_f32 v88, v88
    v_mfma_f32_16x16x32_bf16 v[132:135], a[164:167], v[72:75], v[132:135]
    v_exp_f32 v89, v89
    v_mfma_f32_16x16x32_bf16 v[136:139], a[136:139], v[68:71], v[136:139]
    v_exp_f32 v90, v90
    v_mfma_f32_16x16x32_bf16 v[136:139], a[168:171], v[72:75], v[136:139]
    v_exp_f32 v91, v91
    v_mfma_f32_16x16x32_bf16 v[140:143], a[140:143], v[68:71], v[140:143]
    v_exp_f32 v92, v92
    v_mfma_f32_16x16x32_bf16 v[140:143], a[172:175], v[72:75], v[140:143]
    v_exp_f32 v93, v93
    v_mfma_f32_16x16x32_bf16 v[144:147], a[144:147], v[68:71], v[144:147]
    v_exp_f32 v94, v94
    v_mfma_f32_16x16x32_bf16 v[144:147], a[176:179], v[72:75], v[144:147]
    v_exp_f32 v95, v95
    v_mfma_f32_16x16x32_bf16 v[148:151], a[148:151], v[68:71], v[148:151]
    v_cvt_pk_bf16_f32 v102, v100, v101
    v_cvt_pk_bf16_f32 v101, v98, v99
    v_mfma_f32_16x16x32_bf16 v[148:151], a[180:183], v[72:75], v[148:151]
    v_cvt_pk_bf16_f32 v100, v96, v97
    v_cvt_pk_bf16_f32 v88, v88, v89
    v_mfma_f32_16x16x32_bf16 v[152:155], a[152:155], v[68:71], v[152:155]
    v_cvt_pk_bf16_f32 v89, v90, v91
    v_cvt_pk_bf16_f32 v90, v92, v93
    v_mfma_f32_16x16x32_bf16 v[152:155], a[184:187], v[72:75], v[152:155]
    v_cvt_pk_bf16_f32 v91, v94, v95
    v_mfma_f32_16x16x32_bf16 v[156:159], a[156:159], v[68:71], v[156:159]
    v_mfma_f32_16x16x32_bf16 v[156:159], a[188:191], v[72:75], v[156:159]
    s_waitcnt vmcnt(8) lgkmcnt(0)
    s_barrier
L_U:
    v_mfma_f32_16x16x32_bf16 v[116:119], a[64:67], a[48:51], v[56:59]
    ds_read_b128 a[200:203], v19 offset:8192
    v_add_u32 v10, s27, v7
    v_mfma_f32_16x16x32_bf16 v[116:119], a[68:71], a[52:55], v[116:119]
    ds_read_b128 a[64:67], v10 offset:4096
    v_add_u32 v11, s27, v8
    v_mfma_f32_16x16x32_bf16 v[116:119], a[72:75], a[56:59], v[116:119]
    ds_read_b128 a[68:71], v10 offset:4352
    v_add_u32 v12, s27, v9
    v_mfma_f32_16x16x32_bf16 v[116:119], a[76:79], a[60:63], v[116:119]
    v_exp_f32 v104, v104
    v_mfma_f32_16x16x32_bf16 v[112:115], a[80:83], a[48:51], v[56:59]
    ds_read_b128 a[72:75], v10 offset:4608
    v_mfma_f32_16x16x32_bf16 v[112:115], a[84:87], a[52:55], v[112:115]
    v_exp_f32 v105, v105
    v_mfma_f32_16x16x32_bf16 v[112:115], a[88:91], a[56:59], v[112:115]
    ds_read_b128 a[76:79], v10 offset:4864
    v_cvt_pk_bf16_f32 v104, v104, v105
    v_mfma_f32_16x16x32_bf16 v[112:115], a[92:95], a[60:63], v[112:115]
    v_exp_f32 v106, v106
    v_mfma_f32_16x16x32_bf16 v[120:123], a[96:99], a[48:51], v[56:59]
    ds_read_b128 a[80:83], v10 offset:0
    v_mfma_f32_16x16x32_bf16 v[120:123], a[100:103], a[52:55], v[120:123]
    s_waitcnt lgkmcnt(5)
    v_exp_f32 v107, v107
    v_mfma_f32_16x16x32_bf16 v[120:123], a[104:107], a[56:59], v[120:123]
    ds_read_b128 a[84:87], v10 offset:256
    v_cvt_pk_bf16_f32 v105, v106, v107
    v_mfma_f32_16x16x32_bf16 v[120:123], a[108:111], a[60:63], v[120:123]
    buffer_load_dwordx4 v2, s[8:11], s38 offen offset:0 nt lds
    v_mfma_f32_16x16x32_bf16 v[124:127], a[112:115], a[48:51], v[56:59]
    ds_read_b128 a[88:91], v10 offset:512
    v_mfma_f32_16x16x32_bf16 v[124:127], a[116:119], a[52:55], v[124:127]
    v_exp_f32 v108, v108
    v_mfma_f32_16x16x32_bf16 v[124:127], a[120:123], a[56:59], v[124:127]
    ds_read_b128 a[92:95], v10 offset:768
    v_mfma_f32_16x16x32_bf16 v[124:127], a[124:127], a[60:63], v[124:127]
    v_exp_f32 v109, v109
    v_mfma_f32_16x16x32_bf16 v[160:163], a[128:131], v[84:87], v[160:163]
    ds_read_b128 a[96:99], v10 offset:8192
    v_cvt_pk_bf16_f32 v106, v108, v109
    v_mfma_f32_16x16x32_bf16 v[160:163], a[160:163], v[88:91], v[160:163]
    v_exp_f32 v110, v110
    v_smfmac_f32_16x16x64_bf16 a[232:235], a[224:227], v[84:91], v4
    v_exp_f32 v111, v111
    v_mfma_f32_16x16x32_bf16 v[164:167], a[132:135], v[84:87], v[164:167]
    ds_read_b128 a[100:103], v10 offset:8448
    v_cvt_pk_bf16_f32 v107, v110, v111
    v_mfma_f32_16x16x32_bf16 v[164:167], a[164:167], v[88:91], v[164:167]
    buffer_load_dwordx4 v2, s[8:11], s38 offen offset:1024 nt lds
    v_mfma_f32_16x16x32_bf16 v[168:171], a[136:139], v[84:87], v[168:171]
    ds_read_b128 a[104:107], v10 offset:8704
    v_mfma_f32_16x16x32_bf16 v[168:171], a[168:171], v[88:91], v[168:171]
    s_waitcnt lgkmcnt(3)
    v_exp_f32 v119, v119
    v_mfma_f32_16x16x32_bf16 v[172:175], a[140:143], v[84:87], v[172:175]
    ds_read_b128 a[108:111], v10 offset:8960
    v_mfma_f32_16x16x32_bf16 v[172:175], a[172:175], v[88:91], v[172:175]
    v_exp_f32 v118, v118
    v_mfma_f32_16x16x32_bf16 v[176:179], a[144:147], v[84:87], v[176:179]
    ds_read_b128 a[112:115], v10 offset:12288
    v_cvt_pk_bf16_f32 v119, v118, v119
    v_mfma_f32_16x16x32_bf16 v[176:179], a[176:179], v[88:91], v[176:179]
    v_exp_f32 v117, v117
    v_mfma_f32_16x16x32_bf16 v[180:183], a[148:151], v[84:87], v[180:183]
    ds_read_b128 a[116:119], v10 offset:12544
    v_mfma_f32_16x16x32_bf16 v[180:183], a[180:183], v[88:91], v[180:183]
    v_exp_f32 v116, v116
    v_mfma_f32_16x16x32_bf16 v[184:187], a[152:155], v[84:87], v[184:187]
    ds_read_b128 a[120:123], v10 offset:12800
    v_cvt_pk_bf16_f32 v118, v116, v117
    v_mfma_f32_16x16x32_bf16 v[184:187], a[184:187], v[88:91], v[184:187]
    buffer_store_dwordx4 a[200:203], v21, s[20:23], s30 offen offset:0 nt
    v_mfma_f32_16x16x32_bf16 v[188:191], a[156:159], v[84:87], v[188:191]
    ds_read_b128 a[124:127], v10 offset:13056
    v_mfma_f32_16x16x32_bf16 v[188:191], a[188:191], v[88:91], v[188:191]
    ds_read_b128 a[204:207], v20 offset:9216
    v_mfma_f32_16x16x32_bf16 v[68:71], a[64:67], a[0:3], v[44:47]
    v_exp_f32 v115, v115
    v_mfma_f32_16x16x32_bf16 v[68:71], a[68:71], a[4:7], v[68:71]
    v_exp_f32 v114, v114
    v_mfma_f32_16x16x32_bf16 v[68:71], a[72:75], a[8:11], v[68:71]
    v_exp_f32 v113, v113
    v_mfma_f32_16x16x32_bf16 v[68:71], a[76:79], a[12:15], v[68:71]
    v_exp_f32 v112, v112
    v_mfma_f32_16x16x32_bf16 v[64:67], a[80:83], a[0:3], v[44:47]
    v_exp_f32 v120, v120
    v_mfma_f32_16x16x32_bf16 v[64:67], a[84:87], a[4:7], v[64:67]
    v_exp_f32 v121, v121
    v_mfma_f32_16x16x32_bf16 v[64:67], a[88:91], a[8:11], v[64:67]
    s_waitcnt lgkmcnt(1)
    v_exp_f32 v122, v122
    v_mfma_f32_16x16x32_bf16 v[64:67], a[92:95], a[12:15], v[64:67]
    buffer_load_dwordx4 v3, s[8:11], s38 offen offset:2048 nt lds
    v_mfma_f32_16x16x32_bf16 v[72:75], a[96:99], a[0:3], v[44:47]
    s_waitcnt lgkmcnt(0)
    v_exp_f32 v123, v123
    v_mfma_f32_16x16x32_bf16 v[72:75], a[100:103], a[4:7], v[72:75]
    v_exp_f32 v124, v124
    v_mfma_f32_16x16x32_bf16 v[72:75], a[104:107], a[8:11], v[72:75]
    v_exp_f32 v125, v125
    v_mfma_f32_16x16x32_bf16 v[72:75], a[108:111], a[12:15], v[72:75]
    v_exp_f32 v126, v126
    v_mfma_f32_16x16x32_bf16 v[76:79], a[112:115], a[0:3], v[44:47]
    v_exp_f32 v127, v127
    v_mfma_f32_16x16x32_bf16 v[76:79], a[116:119], a[4:7], v[76:79]
    v_exp_f32 v71, v71
    v_mfma_f32_16x16x32_bf16 v[76:79], a[120:123], a[8:11], v[76:79]
    v_exp_f32 v70, v70
    v_mfma_f32_16x16x32_bf16 v[76:79], a[124:127], a[12:15], v[76:79]
    v_exp_f32 v69, v69
    v_mfma_f32_16x16x32_bf16 v[192:195], a[128:131], v[100:103], v[192:195]
    v_exp_f32 v68, v68
    v_mfma_f32_16x16x32_bf16 v[192:195], a[160:163], v[104:107], v[192:195]
    v_exp_f32 v67, v67
    v_smfmac_f32_16x16x64_bf16 a[236:239], a[224:227], v[100:107], v4
    v_cvt_pk_bf16_f32 v117, v114, v115
    v_mfma_f32_16x16x32_bf16 v[196:199], a[132:135], v[100:103], v[196:199]
    v_exp_f32 v66, v66
    v_mfma_f32_16x16x32_bf16 v[196:199], a[164:167], v[104:107], v[196:199]
    buffer_load_dwordx4 v3, s[8:11], s38 offen offset:3072 nt lds
    v_mfma_f32_16x16x32_bf16 v[200:203], a[136:139], v[100:103], v[200:203]
    s_add_u32 m0, s26, s33
    v_exp_f32 v65, v65
    v_mfma_f32_16x16x32_bf16 v[200:203], a[168:171], v[104:107], v[200:203]
    v_exp_f32 v64, v64
    v_mfma_f32_16x16x32_bf16 v[204:207], a[140:143], v[100:103], v[204:207]
    v_exp_f32 v72, v72
    v_mfma_f32_16x16x32_bf16 v[204:207], a[172:175], v[104:107], v[204:207]
    v_exp_f32 v73, v73
    v_mfma_f32_16x16x32_bf16 v[208:211], a[144:147], v[100:103], v[208:211]
    v_exp_f32 v74, v74
    v_mfma_f32_16x16x32_bf16 v[208:211], a[176:179], v[104:107], v[208:211]
    v_exp_f32 v75, v75
    v_mfma_f32_16x16x32_bf16 v[212:215], a[148:151], v[100:103], v[212:215]
    v_exp_f32 v76, v76
    v_mfma_f32_16x16x32_bf16 v[212:215], a[180:183], v[104:107], v[212:215]
    v_exp_f32 v77, v77
    v_mfma_f32_16x16x32_bf16 v[216:219], a[152:155], v[100:103], v[216:219]
    v_exp_f32 v78, v78
    v_mfma_f32_16x16x32_bf16 v[216:219], a[184:187], v[104:107], v[216:219]
    buffer_load_dwordx4 v2, s[12:15], s38 offen offset:0 nt lds
    v_mfma_f32_16x16x32_bf16 v[220:223], a[156:159], v[100:103], v[220:223]
    v_exp_f32 v79, v79
    v_mfma_f32_16x16x32_bf16 v[220:223], a[188:191], v[104:107], v[220:223]
    v_cvt_pk_bf16_f32 v116, v112, v113
    v_cvt_pk_bf16_f32 v120, v120, v121
    v_mfma_f32_16x16x32_bf16 v[84:87], a[64:67], a[16:19], v[48:51]
    v_cvt_pk_bf16_f32 v121, v122, v123
    v_cvt_pk_bf16_f32 v122, v124, v125
    v_mfma_f32_16x16x32_bf16 v[84:87], a[68:71], a[20:23], v[84:87]
    v_cvt_pk_bf16_f32 v123, v126, v127
    v_cvt_pk_bf16_f32 v71, v70, v71
    v_mfma_f32_16x16x32_bf16 v[84:87], a[72:75], a[24:27], v[84:87]
    v_cvt_pk_bf16_f32 v70, v68, v69
    v_cvt_pk_bf16_f32 v69, v66, v67
    v_mfma_f32_16x16x32_bf16 v[84:87], a[76:79], a[28:31], v[84:87]
    v_cvt_pk_bf16_f32 v68, v64, v65
    v_cvt_pk_bf16_f32 v72, v72, v73
    v_mfma_f32_16x16x32_bf16 v[80:83], a[80:83], a[16:19], v[48:51]
    v_cvt_pk_bf16_f32 v73, v74, v75
    v_cvt_pk_bf16_f32 v74, v76, v77
    v_mfma_f32_16x16x32_bf16 v[80:83], a[84:87], a[20:23], v[80:83]
    v_cvt_pk_bf16_f32 v75, v78, v79
    v_mfma_f32_16x16x32_bf16 v[80:83], a[88:91], a[24:27], v[80:83]
    v_exp_f32 v87, v87
    v_mfma_f32_16x16x32_bf16 v[80:83], a[92:95], a[28:31], v[80:83]
    buffer_store_dwordx4 a[204:207], v21, s[20:23], s30 offen offset:1024 nt
    v_mfma_f32_16x16x32_bf16 v[88:91], a[96:99], a[16:19], v[48:51]
    v_exp_f32 v86, v86
    v_mfma_f32_16x16x32_bf16 v[88:91], a[100:103], a[20:23], v[88:91]
    ds_read_b128 a[208:211], v19 offset:10240
    v_cvt_pk_bf16_f32 v87, v86, v87
    v_mfma_f32_16x16x32_bf16 v[88:91], a[104:107], a[24:27], v[88:91]
    v_exp_f32 v85, v85
    v_mfma_f32_16x16x32_bf16 v[88:91], a[108:111], a[28:31], v[88:91]
    v_exp_f32 v84, v84
    v_mfma_f32_16x16x32_bf16 v[92:95], a[112:115], a[16:19], v[48:51]
    v_exp_f32 v83, v83
    v_mfma_f32_16x16x32_bf16 v[92:95], a[116:119], a[20:23], v[92:95]
    v_exp_f32 v82, v82
    v_mfma_f32_16x16x32_bf16 v[92:95], a[120:123], a[24:27], v[92:95]
    v_exp_f32 v81, v81
    v_mfma_f32_16x16x32_bf16 v[92:95], a[124:127], a[28:31], v[92:95]
    v_exp_f32 v80, v80
    v_mfma_f32_16x16x32_bf16 v[224:227], a[128:131], v[116:119], v[224:227]
    ds_read_b64_tr_b16 a[128:129], v11 offset:0
    v_cvt_pk_bf16_f32 v86, v84, v85
    v_mfma_f32_16x16x32_bf16 v[224:227], a[160:163], v[120:123], v[224:227]
    buffer_load_dwordx4 v3, s[12:15], s38 offen offset:1024 nt lds
    v_smfmac_f32_16x16x64_bf16 a[240:243], a[224:227], v[116:123], v4
    ds_read_b64_tr_b16 a[130:131], v11 offset:4096
    v_mfma_f32_16x16x32_bf16 v[228:231], a[132:135], v[116:119], v[228:231]
    ds_read_b64_tr_b16 a[160:161], v11 offset:8192
    v_cvt_pk_bf16_f32 v85, v82, v83
    v_mfma_f32_16x16x32_bf16 v[228:231], a[164:167], v[120:123], v[228:231]
    ds_read_b64_tr_b16 a[162:163], v11 offset:12288
    v_cvt_pk_bf16_f32 v84, v80, v81
    v_mfma_f32_16x16x32_bf16 v[232:235], a[136:139], v[116:119], v[232:235]
    ds_read_b64_tr_b16 a[132:133], v12 offset:0
    v_mfma_f32_16x16x32_bf16 v[232:235], a[168:171], v[120:123], v[232:235]
    ds_read_b64_tr_b16 a[134:135], v12 offset:4096
    v_mfma_f32_16x16x32_bf16 v[236:239], a[140:143], v[116:119], v[236:239]
    ds_read_b64_tr_b16 a[164:165], v12 offset:8192
    v_mfma_f32_16x16x32_bf16 v[236:239], a[172:175], v[120:123], v[236:239]
    ds_read_b64_tr_b16 a[166:167], v12 offset:12288
    v_mfma_f32_16x16x32_bf16 v[240:243], a[144:147], v[116:119], v[240:243]
    ds_read_b64_tr_b16 a[136:137], v11 offset:256
    v_mfma_f32_16x16x32_bf16 v[240:243], a[176:179], v[120:123], v[240:243]
    ds_read_b64_tr_b16 a[138:139], v11 offset:4352
    v_mfma_f32_16x16x32_bf16 v[244:247], a[148:151], v[116:119], v[244:247]
    ds_read_b64_tr_b16 a[168:169], v11 offset:8448
    v_mfma_f32_16x16x32_bf16 v[244:247], a[180:183], v[120:123], v[244:247]
    buffer_load_dwordx4 v2, s[12:15], s38 offen offset:2048 nt lds
    v_mfma_f32_16x16x32_bf16 v[248:251], a[152:155], v[116:119], v[248:251]
    ds_read_b64_tr_b16 a[170:171], v11 offset:12544
    v_mfma_f32_16x16x32_bf16 v[248:251], a[184:187], v[120:123], v[248:251]
    ds_read_b64_tr_b16 a[140:141], v12 offset:256
    v_mfma_f32_16x16x32_bf16 v[252:255], a[156:159], v[116:119], v[252:255]
    ds_read_b64_tr_b16 a[142:143], v12 offset:4352
    v_mfma_f32_16x16x32_bf16 v[252:255], a[188:191], v[120:123], v[252:255]
    ds_read_b64_tr_b16 a[172:173], v12 offset:8448
    v_mfma_f32_16x16x32_bf16 v[100:103], a[64:67], a[32:35], v[52:55]
    ds_read_b64_tr_b16 a[174:175], v12 offset:12544
    v_mfma_f32_16x16x32_bf16 v[100:103], a[68:71], a[36:39], v[100:103]
    s_waitcnt lgkmcnt(8)
    v_exp_f32 v88, v88
    v_mfma_f32_16x16x32_bf16 v[100:103], a[72:75], a[40:43], v[100:103]
    ds_read_b64_tr_b16 a[144:145], v11 offset:512
    v_mfma_f32_16x16x32_bf16 v[100:103], a[76:79], a[44:47], v[100:103]
    ds_read_b64_tr_b16 a[146:147], v11 offset:4608
    v_mfma_f32_16x16x32_bf16 v[96:99], a[80:83], a[32:35], v[52:55]
    ds_read_b64_tr_b16 a[176:177], v11 offset:8704
    v_mfma_f32_16x16x32_bf16 v[96:99], a[84:87], a[36:39], v[96:99]
    ds_read_b64_tr_b16 a[178:179], v11 offset:12800
    v_mfma_f32_16x16x32_bf16 v[96:99], a[88:91], a[40:43], v[96:99]
    ds_read_b64_tr_b16 a[148:149], v12 offset:512
    v_mfma_f32_16x16x32_bf16 v[96:99], a[92:95], a[44:47], v[96:99]
    buffer_load_dwordx4 v3, s[12:15], s38 offen offset:3072 nt lds
    v_mfma_f32_16x16x32_bf16 v[104:107], a[96:99], a[32:35], v[52:55]
    ds_read_b64_tr_b16 a[150:151], v12 offset:4608
    v_mfma_f32_16x16x32_bf16 v[104:107], a[100:103], a[36:39], v[104:107]
    ds_read_b64_tr_b16 a[180:181], v12 offset:8704
    v_mfma_f32_16x16x32_bf16 v[104:107], a[104:107], a[40:43], v[104:107]
    ds_read_b64_tr_b16 a[182:183], v12 offset:12800
    v_mfma_f32_16x16x32_bf16 v[104:107], a[108:111], a[44:47], v[104:107]
    ds_read_b64_tr_b16 a[152:153], v11 offset:768
    v_mfma_f32_16x16x32_bf16 v[108:111], a[112:115], a[32:35], v[52:55]
    s_waitcnt lgkmcnt(9)
    ds_read_b64_tr_b16 a[154:155], v11 offset:4864
    v_mfma_f32_16x16x32_bf16 v[108:111], a[116:119], a[36:39], v[108:111]
    ds_read_b64_tr_b16 a[184:185], v11 offset:8960
    v_mfma_f32_16x16x32_bf16 v[108:111], a[120:123], a[40:43], v[108:111]
    ds_read_b64_tr_b16 a[186:187], v11 offset:13056
    v_mfma_f32_16x16x32_bf16 v[108:111], a[124:127], a[44:47], v[108:111]
    ds_read_b64_tr_b16 a[156:157], v12 offset:768
    v_exp_f32 v89, v89
    v_mfma_f32_16x16x32_bf16 v[128:131], a[128:131], v[68:71], v[128:131]
    ds_read_b64_tr_b16 a[158:159], v12 offset:4864
    v_cvt_pk_bf16_f32 v88, v88, v89
    v_mfma_f32_16x16x32_bf16 v[128:131], a[160:163], v[72:75], v[128:131]
    buffer_store_dwordx4 a[208:211], v21, s[20:23], s30 offen offset:2048 nt
    v_smfmac_f32_16x16x64_bf16 a[228:231], a[224:227], v[68:75], v4
    ds_read_b64_tr_b16 a[188:189], v12 offset:8960
    v_mfma_f32_16x16x32_bf16 v[132:135], a[132:135], v[68:71], v[132:135]
    ds_read_b64_tr_b16 a[190:191], v12 offset:13056
    v_mfma_f32_16x16x32_bf16 v[132:135], a[164:167], v[72:75], v[132:135]
    s_waitcnt lgkmcnt(8)
    v_exp_f32 v90, v90
    v_mfma_f32_16x16x32_bf16 v[136:139], a[136:139], v[68:71], v[136:139]
    s_add_u32 s38, s35, 81920
    v_exp_f32 v91, v91
    v_mfma_f32_16x16x32_bf16 v[136:139], a[168:171], v[72:75], v[136:139]
    s_add_u32 m0, s27, s32
    v_exp_f32 v92, v92
    v_mfma_f32_16x16x32_bf16 v[140:143], a[140:143], v[68:71], v[140:143]
    ds_read_b128 a[212:215], v20 offset:11264
    v_cvt_pk_bf16_f32 v89, v90, v91
    v_mfma_f32_16x16x32_bf16 v[140:143], a[172:175], v[72:75], v[140:143]
    v_exp_f32 v93, v93
    v_mfma_f32_16x16x32_bf16 v[144:147], a[144:147], v[68:71], v[144:147]
    v_exp_f32 v94, v94
    v_mfma_f32_16x16x32_bf16 v[144:147], a[176:179], v[72:75], v[144:147]
    v_exp_f32 v95, v95
    v_mfma_f32_16x16x32_bf16 v[148:151], a[148:151], v[68:71], v[148:151]
    s_waitcnt lgkmcnt(1)
    v_exp_f32 v103, v103
    v_mfma_f32_16x16x32_bf16 v[148:151], a[180:183], v[72:75], v[148:151]
    v_exp_f32 v102, v102
    v_mfma_f32_16x16x32_bf16 v[152:155], a[152:155], v[68:71], v[152:155]
    v_exp_f32 v101, v101
    v_mfma_f32_16x16x32_bf16 v[152:155], a[184:187], v[72:75], v[152:155]
    v_exp_f32 v100, v100
    v_mfma_f32_16x16x32_bf16 v[156:159], a[156:159], v[68:71], v[156:159]
    s_waitcnt lgkmcnt(0)
    v_exp_f32 v99, v99
    v_mfma_f32_16x16x32_bf16 v[156:159], a[188:191], v[72:75], v[156:159]
    s_waitcnt vmcnt(11)
    s_barrier
    v_mfma_f32_16x16x32_bf16 v[116:119], a[64:67], a[48:51], v[56:59]
    s_mov_b32 s43, s44
    v_exp_f32 v98, v98
    v_add_u32 v10, s25, v7
    v_mfma_f32_16x16x32_bf16 v[116:119], a[68:71], a[52:55], v[116:119]
    ds_read_b128 a[64:67], v10 offset:4096
    v_cvt_pk_bf16_f32 v90, v92, v93
    v_mfma_f32_16x16x32_bf16 v[116:119], a[72:75], a[56:59], v[116:119]
    ds_read_b128 a[68:71], v10 offset:4352
    v_cvt_pk_bf16_f32 v91, v94, v95
    v_mfma_f32_16x16x32_bf16 v[116:119], a[76:79], a[60:63], v[116:119]
    s_mov_b32 s44, s45
    v_exp_f32 v97, v97
    v_mfma_f32_16x16x32_bf16 v[112:115], a[80:83], a[48:51], v[56:59]
    ds_read_b128 a[72:75], v10 offset:4608
    v_add_u32 v11, s25, v8
    v_mfma_f32_16x16x32_bf16 v[112:115], a[84:87], a[52:55], v[112:115]
    v_exp_f32 v96, v96
    v_mfma_f32_16x16x32_bf16 v[112:115], a[88:91], a[56:59], v[112:115]
    ds_read_b128 a[76:79], v10 offset:4864
    v_add_u32 v12, s25, v9
    v_mfma_f32_16x16x32_bf16 v[112:115], a[92:95], a[60:63], v[112:115]
    v_exp_f32 v104, v104
    v_mfma_f32_16x16x32_bf16 v[120:123], a[96:99], a[48:51], v[56:59]
    ds_read_b128 a[80:83], v10 offset:0
    v_cvt_pk_bf16_f32 v103, v102, v103
    v_mfma_f32_16x16x32_bf16 v[120:123], a[100:103], a[52:55], v[120:123]
    v_exp_f32 v105, v105
    v_mfma_f32_16x16x32_bf16 v[120:123], a[104:107], a[56:59], v[120:123]
    ds_read_b128 a[84:87], v10 offset:256
    v_cvt_pk_bf16_f32 v102, v100, v101
    v_mfma_f32_16x16x32_bf16 v[120:123], a[108:111], a[60:63], v[120:123]
    buffer_load_dwordx4 v2, s[8:11], s38 offen offset:0 nt lds
    v_mfma_f32_16x16x32_bf16 v[124:127], a[112:115], a[48:51], v[56:59]
    ds_read_b128 a[88:91], v10 offset:512
    v_cvt_pk_bf16_f32 v101, v98, v99
    v_mfma_f32_16x16x32_bf16 v[124:127], a[116:119], a[52:55], v[124:127]
    v_exp_f32 v106, v106
    v_mfma_f32_16x16x32_bf16 v[124:127], a[120:123], a[56:59], v[124:127]
    ds_read_b128 a[92:95], v10 offset:768
    v_cvt_pk_bf16_f32 v100, v96, v97
    v_mfma_f32_16x16x32_bf16 v[124:127], a[124:127], a[60:63], v[124:127]
    v_exp_f32 v107, v107
    v_mfma_f32_16x16x32_bf16 v[160:163], a[128:131], v[84:87], v[160:163]
    ds_read_b128 a[96:99], v10 offset:8192
    v_cvt_pk_bf16_f32 v104, v104, v105
    v_mfma_f32_16x16x32_bf16 v[160:163], a[160:163], v[88:91], v[160:163]
    buffer_load_dwordx4 v2, s[8:11], s38 offen offset:1024 nt lds
    v_smfmac_f32_16x16x64_bf16 a[232:235], a[224:227], v[84:91], v4
    v_cvt_pk_bf16_f32 v105, v106, v107
    v_mfma_f32_16x16x32_bf16 v[164:167], a[132:135], v[84:87], v[164:167]
    ds_read_b128 a[100:103], v10 offset:8448
    v_mfma_f32_16x16x32_bf16 v[164:167], a[164:167], v[88:91], v[164:167]
    v_exp_f32 v108, v108
    v_mfma_f32_16x16x32_bf16 v[168:171], a[136:139], v[84:87], v[168:171]
    ds_read_b128 a[104:107], v10 offset:8704
    v_mfma_f32_16x16x32_bf16 v[168:171], a[168:171], v[88:91], v[168:171]
    s_waitcnt lgkmcnt(3)
    v_exp_f32 v109, v109
    v_mfma_f32_16x16x32_bf16 v[172:175], a[140:143], v[84:87], v[172:175]
    ds_read_b128 a[108:111], v10 offset:8960
    v_cvt_pk_bf16_f32 v106, v108, v109
    v_mfma_f32_16x16x32_bf16 v[172:175], a[172:175], v[88:91], v[172:175]
    v_exp_f32 v110, v110
    v_mfma_f32_16x16x32_bf16 v[176:179], a[144:147], v[84:87], v[176:179]
    ds_read_b128 a[112:115], v10 offset:12288
    v_mfma_f32_16x16x32_bf16 v[176:179], a[176:179], v[88:91], v[176:179]
    v_exp_f32 v111, v111
    v_mfma_f32_16x16x32_bf16 v[180:183], a[148:151], v[84:87], v[180:183]
    ds_read_b128 a[116:119], v10 offset:12544
    v_cvt_pk_bf16_f32 v107, v110, v111
    v_mfma_f32_16x16x32_bf16 v[180:183], a[180:183], v[88:91], v[180:183]
    buffer_store_dwordx4 a[212:215], v21, s[20:23], s30 offen offset:3072 nt
    v_mfma_f32_16x16x32_bf16 v[184:187], a[152:155], v[84:87], v[184:187]
    ds_read_b128 a[120:123], v10 offset:12800
    v_mfma_f32_16x16x32_bf16 v[184:187], a[184:187], v[88:91], v[184:187]
    ds_read_b128 a[192:195], v19 offset:12288
    v_exp_f32 v119, v119
    v_mfma_f32_16x16x32_bf16 v[188:191], a[156:159], v[84:87], v[188:191]
    ds_read_b128 a[124:127], v10 offset:13056
    v_mfma_f32_16x16x32_bf16 v[188:191], a[188:191], v[88:91], v[188:191]
    v_exp_f32 v118, v118
    v_mfma_f32_16x16x32_bf16 v[68:71], a[64:67], a[0:3], v[44:47]
    v_exp_f32 v117, v117
    v_mfma_f32_16x16x32_bf16 v[68:71], a[68:71], a[4:7], v[68:71]
    v_exp_f32 v116, v116
    v_mfma_f32_16x16x32_bf16 v[68:71], a[72:75], a[8:11], v[68:71]
    v_exp_f32 v115, v115
    v_mfma_f32_16x16x32_bf16 v[68:71], a[76:79], a[12:15], v[68:71]
    v_exp_f32 v114, v114
    v_mfma_f32_16x16x32_bf16 v[64:67], a[80:83], a[0:3], v[44:47]
    v_exp_f32 v113, v113
    v_mfma_f32_16x16x32_bf16 v[64:67], a[84:87], a[4:7], v[64:67]
    s_waitcnt lgkmcnt(1)
    v_exp_f32 v112, v112
    v_mfma_f32_16x16x32_bf16 v[64:67], a[88:91], a[8:11], v[64:67]
    s_waitcnt lgkmcnt(0)
    v_exp_f32 v120, v120
    v_mfma_f32_16x16x32_bf16 v[64:67], a[92:95], a[12:15], v[64:67]
    buffer_load_dwordx4 v3, s[8:11], s38 offen offset:2048 nt lds
    v_mfma_f32_16x16x32_bf16 v[72:75], a[96:99], a[0:3], v[44:47]
    v_exp_f32 v121, v121
    v_mfma_f32_16x16x32_bf16 v[72:75], a[100:103], a[4:7], v[72:75]
    v_exp_f32 v122, v122
    v_mfma_f32_16x16x32_bf16 v[72:75], a[104:107], a[8:11], v[72:75]
    v_exp_f32 v123, v123
    v_mfma_f32_16x16x32_bf16 v[72:75], a[108:111], a[12:15], v[72:75]
    v_exp_f32 v124, v124
    v_mfma_f32_16x16x32_bf16 v[76:79], a[112:115], a[0:3], v[44:47]
    v_exp_f32 v125, v125
    v_mfma_f32_16x16x32_bf16 v[76:79], a[116:119], a[4:7], v[76:79]
    v_exp_f32 v126, v126
    v_mfma_f32_16x16x32_bf16 v[76:79], a[120:123], a[8:11], v[76:79]
    v_exp_f32 v127, v127
    v_mfma_f32_16x16x32_bf16 v[76:79], a[124:127], a[12:15], v[76:79]
    buffer_load_dwordx4 v3, s[8:11], s38 offen offset:3072 nt lds
    v_mfma_f32_16x16x32_bf16 v[192:195], a[128:131], v[100:103], v[192:195]
    s_add_u32 m0, s27, s33
    v_exp_f32 v71, v71
    v_mfma_f32_16x16x32_bf16 v[192:195], a[160:163], v[104:107], v[192:195]
    v_exp_f32 v70, v70
    v_smfmac_f32_16x16x64_bf16 a[236:239], a[224:227], v[100:107], v4
    v_cvt_pk_bf16_f32 v119, v118, v119
    v_mfma_f32_16x16x32_bf16 v[196:199], a[132:135], v[100:103], v[196:199]
    v_exp_f32 v69, v69
    v_mfma_f32_16x16x32_bf16 v[196:199], a[164:167], v[104:107], v[196:199]
    v_exp_f32 v68, v68
    v_mfma_f32_16x16x32_bf16 v[200:203], a[136:139], v[100:103], v[200:203]
    v_exp_f32 v67, v67
    v_mfma_f32_16x16x32_bf16 v[200:203], a[168:171], v[104:107], v[200:203]
    v_exp_f32 v66, v66
    v_mfma_f32_16x16x32_bf16 v[204:207], a[140:143], v[100:103], v[204:207]
    v_exp_f32 v65, v65
    v_mfma_f32_16x16x32_bf16 v[204:207], a[172:175], v[104:107], v[204:207]
    buffer_load_dwordx4 v2, s[12:15], s38 offen offset:0 nt lds
    v_mfma_f32_16x16x32_bf16 v[208:211], a[144:147], v[100:103], v[208:211]
    v_exp_f32 v64, v64
    v_mfma_f32_16x16x32_bf16 v[208:211], a[176:179], v[104:107], v[208:211]
    v_exp_f32 v72, v72
    v_mfma_f32_16x16x32_bf16 v[212:215], a[148:151], v[100:103], v[212:215]
    v_exp_f32 v73, v73
    v_mfma_f32_16x16x32_bf16 v[212:215], a[180:183], v[104:107], v[212:215]
    v_exp_f32 v74, v74
    v_mfma_f32_16x16x32_bf16 v[216:219], a[152:155], v[100:103], v[216:219]
    v_exp_f32 v75, v75
    v_mfma_f32_16x16x32_bf16 v[216:219], a[184:187], v[104:107], v[216:219]
    v_exp_f32 v76, v76
    v_mfma_f32_16x16x32_bf16 v[220:223], a[156:159], v[100:103], v[220:223]
    v_exp_f32 v77, v77
    v_mfma_f32_16x16x32_bf16 v[220:223], a[188:191], v[104:107], v[220:223]
    ds_read_b128 a[196:199], v20 offset:13312
    v_cvt_pk_bf16_f32 v118, v116, v117
    v_mfma_f32_16x16x32_bf16 v[84:87], a[64:67], a[16:19], v[48:51]
    v_exp_f32 v78, v78
    v_mfma_f32_16x16x32_bf16 v[84:87], a[68:71], a[20:23], v[84:87]
    v_exp_f32 v79, v79
    v_mfma_f32_16x16x32_bf16 v[84:87], a[72:75], a[24:27], v[84:87]
    v_cvt_pk_bf16_f32 v117, v114, v115
    v_cvt_pk_bf16_f32 v116, v112, v113
    v_mfma_f32_16x16x32_bf16 v[84:87], a[76:79], a[28:31], v[84:87]
    buffer_store_dwordx4 a[192:195], v21, s[20:23], s31 offen offset:0 nt
    v_mfma_f32_16x16x32_bf16 v[80:83], a[80:83], a[16:19], v[48:51]
    v_cvt_pk_bf16_f32 v120, v120, v121
    v_cvt_pk_bf16_f32 v121, v122, v123
    v_mfma_f32_16x16x32_bf16 v[80:83], a[84:87], a[20:23], v[80:83]
    v_cvt_pk_bf16_f32 v122, v124, v125
    v_cvt_pk_bf16_f32 v123, v126, v127
    v_mfma_f32_16x16x32_bf16 v[80:83], a[88:91], a[24:27], v[80:83]
    v_exp_f32 v87, v87
    v_mfma_f32_16x16x32_bf16 v[80:83], a[92:95], a[28:31], v[80:83]
    s_waitcnt lgkmcnt(0)
    v_exp_f32 v86, v86
    v_mfma_f32_16x16x32_bf16 v[88:91], a[96:99], a[16:19], v[48:51]
    v_exp_f32 v85, v85
    v_mfma_f32_16x16x32_bf16 v[88:91], a[100:103], a[20:23], v[88:91]
    v_exp_f32 v84, v84
    v_mfma_f32_16x16x32_bf16 v[88:91], a[104:107], a[24:27], v[88:91]
    v_exp_f32 v83, v83
    v_mfma_f32_16x16x32_bf16 v[88:91], a[108:111], a[28:31], v[88:91]
    buffer_load_dwordx4 v3, s[12:15], s38 offen offset:1024 nt lds
    v_mfma_f32_16x16x32_bf16 v[92:95], a[112:115], a[16:19], v[48:51]
    v_exp_f32 v82, v82
    v_mfma_f32_16x16x32_bf16 v[92:95], a[116:119], a[20:23], v[92:95]
    v_exp_f32 v81, v81
    v_mfma_f32_16x16x32_bf16 v[92:95], a[120:123], a[24:27], v[92:95]
    v_exp_f32 v80, v80
    v_mfma_f32_16x16x32_bf16 v[92:95], a[124:127], a[28:31], v[92:95]
    v_exp_f32 v88, v88
    v_mfma_f32_16x16x32_bf16 v[224:227], a[128:131], v[116:119], v[224:227]
    ds_read_b64_tr_b16 a[128:129], v11 offset:0
    v_cvt_pk_bf16_f32 v71, v70, v71
    v_mfma_f32_16x16x32_bf16 v[224:227], a[160:163], v[120:123], v[224:227]
    ds_read_b64_tr_b16 a[130:131], v11 offset:4096
    v_cvt_pk_bf16_f32 v70, v68, v69
    v_smfmac_f32_16x16x64_bf16 a[240:243], a[224:227], v[116:123], v4
    ds_read_b64_tr_b16 a[160:161], v11 offset:8192
    v_mfma_f32_16x16x32_bf16 v[228:231], a[132:135], v[116:119], v[228:231]
    ds_read_b64_tr_b16 a[162:163], v11 offset:12288
    v_cvt_pk_bf16_f32 v69, v66, v67
    v_mfma_f32_16x16x32_bf16 v[228:231], a[164:167], v[120:123], v[228:231]
    ds_read_b64_tr_b16 a[132:133], v12 offset:0
    v_cvt_pk_bf16_f32 v68, v64, v65
    v_mfma_f32_16x16x32_bf16 v[232:235], a[136:139], v[116:119], v[232:235]
    ds_read_b64_tr_b16 a[134:135], v12 offset:4096
    v_cvt_pk_bf16_f32 v72, v72, v73
    v_mfma_f32_16x16x32_bf16 v[232:235], a[168:171], v[120:123], v[232:235]
    buffer_load_dwordx4 v2, s[12:15], s38 offen offset:2048 nt lds
    v_mfma_f32_16x16x32_bf16 v[236:239], a[140:143], v[116:119], v[236:239]
    ds_read_b64_tr_b16 a[164:165], v12 offset:8192
    v_cvt_pk_bf16_f32 v73, v74, v75
    v_mfma_f32_16x16x32_bf16 v[236:239], a[172:175], v[120:123], v[236:239]
    ds_read_b64_tr_b16 a[166:167], v12 offset:12288
    v_cvt_pk_bf16_f32 v74, v76, v77
    v_mfma_f32_16x16x32_bf16 v[240:243], a[144:147], v[116:119], v[240:243]
    ds_read_b64_tr_b16 a[136:137], v11 offset:256
    v_cvt_pk_bf16_f32 v75, v78, v79
    v_mfma_f32_16x16x32_bf16 v[240:243], a[176:179], v[120:123], v[240:243]
    ds_read_b64_tr_b16 a[138:139], v11 offset:4352
    v_cvt_pk_bf16_f32 v87, v86, v87
    v_mfma_f32_16x16x32_bf16 v[244:247], a[148:151], v[116:119], v[244:247]
    ds_read_b64_tr_b16 a[168:169], v11 offset:8448
    v_cvt_pk_bf16_f32 v86, v84, v85
    v_mfma_f32_16x16x32_bf16 v[244:247], a[180:183], v[120:123], v[244:247]
    ds_read_b64_tr_b16 a[170:171], v11 offset:12544
    v_cvt_pk_bf16_f32 v85, v82, v83
    v_mfma_f32_16x16x32_bf16 v[248:251], a[152:155], v[116:119], v[248:251]
    ds_read_b64_tr_b16 a[140:141], v12 offset:256
    v_cvt_pk_bf16_f32 v84, v80, v81
    v_mfma_f32_16x16x32_bf16 v[248:251], a[184:187], v[120:123], v[248:251]
    buffer_load_dwordx4 v3, s[12:15], s38 offen offset:3072 nt lds
    v_mfma_f32_16x16x32_bf16 v[252:255], a[156:159], v[116:119], v[252:255]
    ds_read_b64_tr_b16 a[142:143], v12 offset:4352
    v_mfma_f32_16x16x32_bf16 v[252:255], a[188:191], v[120:123], v[252:255]
    ds_read_b64_tr_b16 a[172:173], v12 offset:8448
    v_mfma_f32_16x16x32_bf16 v[100:103], a[64:67], a[32:35], v[52:55]
    ds_read_b64_tr_b16 a[174:175], v12 offset:12544
    v_mfma_f32_16x16x32_bf16 v[100:103], a[68:71], a[36:39], v[100:103]
    s_waitcnt lgkmcnt(8)
    v_exp_f32 v89, v89
    v_mfma_f32_16x16x32_bf16 v[100:103], a[72:75], a[40:43], v[100:103]
    ds_read_b64_tr_b16 a[144:145], v11 offset:512
    v_cvt_pk_bf16_f32 v88, v88, v89
    v_mfma_f32_16x16x32_bf16 v[100:103], a[76:79], a[44:47], v[100:103]
    ds_read_b64_tr_b16 a[146:147], v11 offset:4608
    v_mfma_f32_16x16x32_bf16 v[96:99], a[80:83], a[32:35], v[52:55]
    ds_read_b64_tr_b16 a[176:177], v11 offset:8704
    v_mfma_f32_16x16x32_bf16 v[96:99], a[84:87], a[36:39], v[96:99]
    ds_read_b64_tr_b16 a[178:179], v11 offset:12800
    v_mfma_f32_16x16x32_bf16 v[96:99], a[88:91], a[40:43], v[96:99]
    ds_read_b64_tr_b16 a[148:149], v12 offset:512
    v_mfma_f32_16x16x32_bf16 v[96:99], a[92:95], a[44:47], v[96:99]
    buffer_store_dwordx4 a[196:199], v21, s[20:23], s31 offen offset:1024 nt
    v_mfma_f32_16x16x32_bf16 v[104:107], a[96:99], a[32:35], v[52:55]
    ds_read_b64_tr_b16 a[150:151], v12 offset:4608
    v_mfma_f32_16x16x32_bf16 v[104:107], a[100:103], a[36:39], v[104:107]
    ds_read_b64_tr_b16 a[180:181], v12 offset:8704
    v_mfma_f32_16x16x32_bf16 v[104:107], a[104:107], a[40:43], v[104:107]
    ds_read_b64_tr_b16 a[182:183], v12 offset:12800
    v_mfma_f32_16x16x32_bf16 v[104:107], a[108:111], a[44:47], v[104:107]
    s_mov_b32 m0, s58
    ds_read_b64_tr_b16 a[152:153], v11 offset:768
    v_mfma_f32_16x16x32_bf16 v[108:111], a[112:115], a[32:35], v[52:55]
    s_waitcnt lgkmcnt(9)
    ds_read_b64_tr_b16 a[154:155], v11 offset:4864
    v_mfma_f32_16x16x32_bf16 v[108:111], a[116:119], a[36:39], v[108:111]
    ds_read_b64_tr_b16 a[184:185], v11 offset:8960
    v_mfma_f32_16x16x32_bf16 v[108:111], a[120:123], a[40:43], v[108:111]
    ds_read_b64_tr_b16 a[186:187], v11 offset:13056
    v_mfma_f32_16x16x32_bf16 v[108:111], a[124:127], a[44:47], v[108:111]
    ds_read_b64_tr_b16 a[156:157], v12 offset:768
    v_exp_f32 v90, v90
    v_mfma_f32_16x16x32_bf16 v[128:131], a[128:131], v[68:71], v[128:131]
    ds_read_b64_tr_b16 a[158:159], v12 offset:4864
    v_mfma_f32_16x16x32_bf16 v[128:131], a[160:163], v[72:75], v[128:131]
    buffer_load_dwordx4 v2, s[16:19], s28 offen offset:0 nt lds
    v_smfmac_f32_16x16x64_bf16 a[228:231], a[224:227], v[68:75], v4
    ds_read_b64_tr_b16 a[188:189], v12 offset:8960
    v_mfma_f32_16x16x32_bf16 v[132:135], a[132:135], v[68:71], v[132:135]
    ds_read_b64_tr_b16 a[190:191], v12 offset:13056
    v_mfma_f32_16x16x32_bf16 v[132:135], a[164:167], v[72:75], v[132:135]
    s_waitcnt lgkmcnt(8)
    v_exp_f32 v91, v91
    v_mfma_f32_16x16x32_bf16 v[136:139], a[136:139], v[68:71], v[136:139]
    s_add_u32 s38, s35, 98304
    v_exp_f32 v92, v92
    v_mfma_f32_16x16x32_bf16 v[136:139], a[168:171], v[72:75], v[136:139]
    s_add_u32 m0, s25, s32
    v_exp_f32 v93, v93
    v_mfma_f32_16x16x32_bf16 v[140:143], a[140:143], v[68:71], v[140:143]
    ds_read_b128 a[200:203], v19 offset:14336
    v_cvt_pk_bf16_f32 v89, v90, v91
    v_mfma_f32_16x16x32_bf16 v[140:143], a[172:175], v[72:75], v[140:143]
    v_exp_f32 v94, v94
    v_mfma_f32_16x16x32_bf16 v[144:147], a[144:147], v[68:71], v[144:147]
    v_exp_f32 v95, v95
    v_mfma_f32_16x16x32_bf16 v[144:147], a[176:179], v[72:75], v[144:147]
    v_exp_f32 v103, v103
    v_mfma_f32_16x16x32_bf16 v[148:151], a[148:151], v[68:71], v[148:151]
    s_waitcnt lgkmcnt(1)
    v_exp_f32 v102, v102
    v_mfma_f32_16x16x32_bf16 v[148:151], a[180:183], v[72:75], v[148:151]
    v_exp_f32 v101, v101
    v_mfma_f32_16x16x32_bf16 v[152:155], a[152:155], v[68:71], v[152:155]
    v_exp_f32 v100, v100
    v_mfma_f32_16x16x32_bf16 v[152:155], a[184:187], v[72:75], v[152:155]
    v_exp_f32 v99, v99
    v_mfma_f32_16x16x32_bf16 v[156:159], a[156:159], v[68:71], v[156:159]
    s_waitcnt lgkmcnt(0)
    v_exp_f32 v98, v98
    v_mfma_f32_16x16x32_bf16 v[156:159], a[188:191], v[72:75], v[156:159]
    s_waitcnt vmcnt(13)
    s_barrier
    v_mfma_f32_16x16x32_bf16 v[116:119], a[64:67], a[48:51], v[56:59]
    v_exp_f32 v97, v97
    v_add_u32 v10, s26, v7
    v_mfma_f32_16x16x32_bf16 v[116:119], a[68:71], a[52:55], v[116:119]
    ds_read_b128 a[64:67], v10 offset:4096
    v_cvt_pk_bf16_f32 v90, v92, v93
    v_mfma_f32_16x16x32_bf16 v[116:119], a[72:75], a[56:59], v[116:119]
    ds_read_b128 a[68:71], v10 offset:4352
    v_cvt_pk_bf16_f32 v91, v94, v95
    v_mfma_f32_16x16x32_bf16 v[116:119], a[76:79], a[60:63], v[116:119]
    v_exp_f32 v96, v96
    v_mfma_f32_16x16x32_bf16 v[112:115], a[80:83], a[48:51], v[56:59]
    ds_read_b128 a[72:75], v10 offset:4608
    v_add_u32 v11, s26, v8
    v_mfma_f32_16x16x32_bf16 v[112:115], a[84:87], a[52:55], v[112:115]
    v_exp_f32 v104, v104
    v_mfma_f32_16x16x32_bf16 v[112:115], a[88:91], a[56:59], v[112:115]
    ds_read_b128 a[76:79], v10 offset:4864
    v_add_u32 v12, s26, v9
    v_mfma_f32_16x16x32_bf16 v[112:115], a[92:95], a[60:63], v[112:115]
    v_exp_f32 v105, v105
    v_mfma_f32_16x16x32_bf16 v[120:123], a[96:99], a[48:51], v[56:59]
    ds_read_b128 a[80:83], v10 offset:0
    v_cvt_pk_bf16_f32 v103, v102, v103
    v_mfma_f32_16x16x32_bf16 v[120:123], a[100:103], a[52:55], v[120:123]
    v_exp_f32 v106, v106
    v_mfma_f32_16x16x32_bf16 v[120:123], a[104:107], a[56:59], v[120:123]
    ds_read_b128 a[84:87], v10 offset:256
    v_cvt_pk_bf16_f32 v102, v100, v101
    v_mfma_f32_16x16x32_bf16 v[120:123], a[108:111], a[60:63], v[120:123]
    buffer_load_dwordx4 v2, s[8:11], s38 offen offset:0 nt lds
    v_mfma_f32_16x16x32_bf16 v[124:127], a[112:115], a[48:51], v[56:59]
    ds_read_b128 a[88:91], v10 offset:512
    v_cvt_pk_bf16_f32 v101, v98, v99
    v_mfma_f32_16x16x32_bf16 v[124:127], a[116:119], a[52:55], v[124:127]
    v_exp_f32 v107, v107
    v_mfma_f32_16x16x32_bf16 v[124:127], a[120:123], a[56:59], v[124:127]
    ds_read_b128 a[92:95], v10 offset:768
    v_cvt_pk_bf16_f32 v100, v96, v97
    v_mfma_f32_16x16x32_bf16 v[124:127], a[124:127], a[60:63], v[124:127]
    v_exp_f32 v108, v108
    v_mfma_f32_16x16x32_bf16 v[160:163], a[128:131], v[84:87], v[160:163]
    ds_read_b128 a[96:99], v10 offset:8192
    v_cvt_pk_bf16_f32 v104, v104, v105
    v_mfma_f32_16x16x32_bf16 v[160:163], a[160:163], v[88:91], v[160:163]
    buffer_load_dwordx4 v2, s[8:11], s38 offen offset:1024 nt lds
    v_smfmac_f32_16x16x64_bf16 a[232:235], a[224:227], v[84:91], v4
    v_cvt_pk_bf16_f32 v105, v106, v107
    v_mfma_f32_16x16x32_bf16 v[164:167], a[132:135], v[84:87], v[164:167]
    ds_read_b128 a[100:103], v10 offset:8448
    v_mfma_f32_16x16x32_bf16 v[164:167], a[164:167], v[88:91], v[164:167]
    v_exp_f32 v109, v109
    v_mfma_f32_16x16x32_bf16 v[168:171], a[136:139], v[84:87], v[168:171]
    ds_read_b128 a[104:107], v10 offset:8704
    v_cvt_pk_bf16_f32 v106, v108, v109
    v_mfma_f32_16x16x32_bf16 v[168:171], a[168:171], v[88:91], v[168:171]
    s_waitcnt lgkmcnt(3)
    v_exp_f32 v110, v110
    v_mfma_f32_16x16x32_bf16 v[172:175], a[140:143], v[84:87], v[172:175]
    ds_read_b128 a[108:111], v10 offset:8960
    v_mfma_f32_16x16x32_bf16 v[172:175], a[172:175], v[88:91], v[172:175]
    v_exp_f32 v111, v111
    v_mfma_f32_16x16x32_bf16 v[176:179], a[144:147], v[84:87], v[176:179]
    ds_read_b128 a[112:115], v10 offset:12288
    v_cvt_pk_bf16_f32 v107, v110, v111
    v_mfma_f32_16x16x32_bf16 v[176:179], a[176:179], v[88:91], v[176:179]
    v_exp_f32 v119, v119
    v_mfma_f32_16x16x32_bf16 v[180:183], a[148:151], v[84:87], v[180:183]
    ds_read_b128 a[116:119], v10 offset:12544
    v_mfma_f32_16x16x32_bf16 v[180:183], a[180:183], v[88:91], v[180:183]
    buffer_store_dwordx4 a[200:203], v21, s[20:23], s31 offen offset:2048 nt
    v_mfma_f32_16x16x32_bf16 v[184:187], a[152:155], v[84:87], v[184:187]
    ds_read_b128 a[120:123], v10 offset:12800
    v_mfma_f32_16x16x32_bf16 v[184:187], a[184:187], v[88:91], v[184:187]
    ds_read_b128 a[204:207], v20 offset:15360
    v_exp_f32 v118, v118
    v_mfma_f32_16x16x32_bf16 v[188:191], a[156:159], v[84:87], v[188:191]
    ds_read_b128 a[124:127], v10 offset:13056
    v_cvt_pk_bf16_f32 v119, v118, v119
    v_mfma_f32_16x16x32_bf16 v[188:191], a[188:191], v[88:91], v[188:191]
    v_exp_f32 v117, v117
    v_mfma_f32_16x16x32_bf16 v[68:71], a[64:67], a[0:3], v[44:47]
    v_exp_f32 v116, v116
    v_mfma_f32_16x16x32_bf16 v[68:71], a[68:71], a[4:7], v[68:71]
    v_exp_f32 v115, v115
    v_mfma_f32_16x16x32_bf16 v[68:71], a[72:75], a[8:11], v[68:71]
    v_exp_f32 v114, v114
    v_mfma_f32_16x16x32_bf16 v[68:71], a[76:79], a[12:15], v[68:71]
    v_exp_f32 v113, v113
    v_mfma_f32_16x16x32_bf16 v[64:67], a[80:83], a[0:3], v[44:47]
    v_exp_f32 v112, v112
    v_mfma_f32_16x16x32_bf16 v[64:67], a[84:87], a[4:7], v[64:67]
    s_waitcnt lgkmcnt(1)
    v_exp_f32 v120, v120
    v_mfma_f32_16x16x32_bf16 v[64:67], a[88:91], a[8:11], v[64:67]
    s_waitcnt lgkmcnt(0)
    v_exp_f32 v121, v121
    v_mfma_f32_16x16x32_bf16 v[64:67], a[92:95], a[12:15], v[64:67]
    buffer_load_dwordx4 v3, s[8:11], s38 offen offset:2048 nt lds
    v_mfma_f32_16x16x32_bf16 v[72:75], a[96:99], a[0:3], v[44:47]
    v_exp_f32 v122, v122
    v_mfma_f32_16x16x32_bf16 v[72:75], a[100:103], a[4:7], v[72:75]
    v_exp_f32 v123, v123
    v_mfma_f32_16x16x32_bf16 v[72:75], a[104:107], a[8:11], v[72:75]
    v_exp_f32 v124, v124
    v_mfma_f32_16x16x32_bf16 v[72:75], a[108:111], a[12:15], v[72:75]
    v_exp_f32 v125, v125
    v_mfma_f32_16x16x32_bf16 v[76:79], a[112:115], a[0:3], v[44:47]
    v_exp_f32 v126, v126
    v_mfma_f32_16x16x32_bf16 v[76:79], a[116:119], a[4:7], v[76:79]
    v_exp_f32 v127, v127
    v_mfma_f32_16x16x32_bf16 v[76:79], a[120:123], a[8:11], v[76:79]
    v_exp_f32 v71, v71
    v_mfma_f32_16x16x32_bf16 v[76:79], a[124:127], a[12:15], v[76:79]
    buffer_load_dwordx4 v3, s[8:11], s38 offen offset:3072 nt lds
    v_mfma_f32_16x16x32_bf16 v[192:195], a[128:131], v[100:103], v[192:195]
    s_add_u32 m0, s25, s33
    v_exp_f32 v70, v70
    v_mfma_f32_16x16x32_bf16 v[192:195], a[160:163], v[104:107], v[192:195]
    v_exp_f32 v69, v69
    v_smfmac_f32_16x16x64_bf16 a[236:239], a[224:227], v[100:107], v4
    v_cvt_pk_bf16_f32 v118, v116, v117
    v_mfma_f32_16x16x32_bf16 v[196:199], a[132:135], v[100:103], v[196:199]
    v_exp_f32 v68, v68
    v_mfma_f32_16x16x32_bf16 v[196:199], a[164:167], v[104:107], v[196:199]
    v_exp_f32 v67, v67
    v_mfma_f32_16x16x32_bf16 v[200:203], a[136:139], v[100:103], v[200:203]
    v_exp_f32 v66, v66
    v_mfma_f32_16x16x32_bf16 v[200:203], a[168:171], v[104:107], v[200:203]
    v_exp_f32 v65, v65
    v_mfma_f32_16x16x32_bf16 v[204:207], a[140:143], v[100:103], v[204:207]
    v_exp_f32 v64, v64
    v_mfma_f32_16x16x32_bf16 v[204:207], a[172:175], v[104:107], v[204:207]
    buffer_load_dwordx4 v2, s[12:15], s38 offen offset:0 nt lds
    v_mfma_f32_16x16x32_bf16 v[208:211], a[144:147], v[100:103], v[208:211]
    v_exp_f32 v72, v72
    v_mfma_f32_16x16x32_bf16 v[208:211], a[176:179], v[104:107], v[208:211]
    v_exp_f32 v73, v73
    v_mfma_f32_16x16x32_bf16 v[212:215], a[148:151], v[100:103], v[212:215]
    v_exp_f32 v74, v74
    v_mfma_f32_16x16x32_bf16 v[212:215], a[180:183], v[104:107], v[212:215]
    v_exp_f32 v75, v75
    v_mfma_f32_16x16x32_bf16 v[216:219], a[152:155], v[100:103], v[216:219]
    v_exp_f32 v76, v76
    v_mfma_f32_16x16x32_bf16 v[216:219], a[184:187], v[104:107], v[216:219]
    v_exp_f32 v77, v77
    v_mfma_f32_16x16x32_bf16 v[220:223], a[156:159], v[100:103], v[220:223]
    v_exp_f32 v78, v78
    v_mfma_f32_16x16x32_bf16 v[220:223], a[188:191], v[104:107], v[220:223]
    v_exp_f32 v79, v79
    v_mfma_f32_16x16x32_bf16 v[84:87], a[64:67], a[16:19], v[48:51]
    v_cvt_pk_bf16_f32 v117, v114, v115
    v_cvt_pk_bf16_f32 v116, v112, v113
    v_mfma_f32_16x16x32_bf16 v[84:87], a[68:71], a[20:23], v[84:87]
    v_cvt_pk_bf16_f32 v120, v120, v121
    v_cvt_pk_bf16_f32 v121, v122, v123
    v_mfma_f32_16x16x32_bf16 v[84:87], a[72:75], a[24:27], v[84:87]
    v_cvt_pk_bf16_f32 v122, v124, v125
    v_cvt_pk_bf16_f32 v123, v126, v127
    v_mfma_f32_16x16x32_bf16 v[84:87], a[76:79], a[28:31], v[84:87]
    buffer_store_dwordx4 a[204:207], v21, s[20:23], s31 offen offset:3072 nt
    v_mfma_f32_16x16x32_bf16 v[80:83], a[80:83], a[16:19], v[48:51]
    s_add_u32 s20, s6, s46
    s_addc_u32 s21, s7, 0
    v_cvt_pk_bf16_f32 v71, v70, v71
    v_mfma_f32_16x16x32_bf16 v[80:83], a[84:87], a[20:23], v[80:83]
    s_mov_b32 s22, s50
    v_cvt_pk_bf16_f32 v70, v68, v69
    v_cvt_pk_bf16_f32 v69, v66, v67
    v_mfma_f32_16x16x32_bf16 v[80:83], a[88:91], a[24:27], v[80:83]
    v_exp_f32 v87, v87
    v_mfma_f32_16x16x32_bf16 v[80:83], a[92:95], a[28:31], v[80:83]
    v_exp_f32 v86, v86
    v_mfma_f32_16x16x32_bf16 v[88:91], a[96:99], a[16:19], v[48:51]
    v_exp_f32 v85, v85
    v_mfma_f32_16x16x32_bf16 v[88:91], a[100:103], a[20:23], v[88:91]
    v_exp_f32 v84, v84
    v_mfma_f32_16x16x32_bf16 v[88:91], a[104:107], a[24:27], v[88:91]
    v_exp_f32 v83, v83
    v_mfma_f32_16x16x32_bf16 v[88:91], a[108:111], a[28:31], v[88:91]
    buffer_load_dwordx4 v3, s[12:15], s38 offen offset:1024 nt lds
    v_mfma_f32_16x16x32_bf16 v[92:95], a[112:115], a[16:19], v[48:51]
    v_exp_f32 v82, v82
    v_mfma_f32_16x16x32_bf16 v[92:95], a[116:119], a[20:23], v[92:95]
    v_exp_f32 v81, v81
    v_mfma_f32_16x16x32_bf16 v[92:95], a[120:123], a[24:27], v[92:95]
    v_exp_f32 v80, v80
    v_mfma_f32_16x16x32_bf16 v[92:95], a[124:127], a[28:31], v[92:95]
    v_exp_f32 v88, v88
    v_mfma_f32_16x16x32_bf16 v[224:227], a[128:131], v[116:119], v[224:227]
    ds_read_b64_tr_b16 a[128:129], v11 offset:0
    v_cvt_pk_bf16_f32 v68, v64, v65
    v_mfma_f32_16x16x32_bf16 v[224:227], a[160:163], v[120:123], v[224:227]
    ds_read_b64_tr_b16 a[130:131], v11 offset:4096
    v_cvt_pk_bf16_f32 v72, v72, v73
    v_smfmac_f32_16x16x64_bf16 a[240:243], a[224:227], v[116:123], v4
    ds_read_b64_tr_b16 a[160:161], v11 offset:8192
    v_mfma_f32_16x16x32_bf16 v[228:231], a[132:135], v[116:119], v[228:231]
    ds_read_b64_tr_b16 a[162:163], v11 offset:12288
    v_cvt_pk_bf16_f32 v73, v74, v75
    v_mfma_f32_16x16x32_bf16 v[228:231], a[164:167], v[120:123], v[228:231]
    ds_read_b64_tr_b16 a[132:133], v12 offset:0
    v_cvt_pk_bf16_f32 v74, v76, v77
    v_mfma_f32_16x16x32_bf16 v[232:235], a[136:139], v[116:119], v[232:235]
    ds_read_b64_tr_b16 a[134:135], v12 offset:4096
    v_cvt_pk_bf16_f32 v75, v78, v79
    v_mfma_f32_16x16x32_bf16 v[232:235], a[168:171], v[120:123], v[232:235]
    buffer_load_dwordx4 v2, s[12:15], s38 offen offset:2048 nt lds
    v_mfma_f32_16x16x32_bf16 v[236:239], a[140:143], v[116:119], v[236:239]
    ds_read_b64_tr_b16 a[164:165], v12 offset:8192
    v_cvt_pk_bf16_f32 v87, v86, v87
    v_mfma_f32_16x16x32_bf16 v[236:239], a[172:175], v[120:123], v[236:239]
    ds_read_b64_tr_b16 a[166:167], v12 offset:12288
    v_cvt_pk_bf16_f32 v86, v84, v85
    v_mfma_f32_16x16x32_bf16 v[240:243], a[144:147], v[116:119], v[240:243]
    ds_read_b64_tr_b16 a[136:137], v11 offset:256
    v_cvt_pk_bf16_f32 v85, v82, v83
    v_mfma_f32_16x16x32_bf16 v[240:243], a[176:179], v[120:123], v[240:243]
    ds_read_b64_tr_b16 a[138:139], v11 offset:4352
    v_cvt_pk_bf16_f32 v84, v80, v81
    v_mfma_f32_16x16x32_bf16 v[244:247], a[148:151], v[116:119], v[244:247]
    ds_read_b64_tr_b16 a[168:169], v11 offset:8448
    v_mfma_f32_16x16x32_bf16 v[244:247], a[180:183], v[120:123], v[244:247]
    ds_read_b64_tr_b16 a[170:171], v11 offset:12544
    v_mfma_f32_16x16x32_bf16 v[248:251], a[152:155], v[116:119], v[248:251]
    ds_read_b64_tr_b16 a[140:141], v12 offset:256
    v_mfma_f32_16x16x32_bf16 v[248:251], a[184:187], v[120:123], v[248:251]
    buffer_load_dwordx4 v3, s[12:15], s38 offen offset:3072 nt lds
    v_mfma_f32_16x16x32_bf16 v[252:255], a[156:159], v[116:119], v[252:255]
    s_mov_b32 m0, s58
    v_exp_f32 v89, v89
    v_mfma_f32_16x16x32_bf16 v[252:255], a[188:191], v[120:123], v[252:255]
    ds_read_b64_tr_b16 a[142:143], v12 offset:4352
    v_cvt_pk_bf16_f32 v88, v88, v89
    v_mfma_f32_16x16x32_bf16 v[100:103], a[64:67], a[32:35], v[52:55]
    ds_read_b64_tr_b16 a[172:173], v12 offset:8448
    v_mfma_f32_16x16x32_bf16 v[100:103], a[68:71], a[36:39], v[100:103]
    ds_read_b64_tr_b16 a[174:175], v12 offset:12544
    v_mfma_f32_16x16x32_bf16 v[100:103], a[72:75], a[40:43], v[100:103]
    s_waitcnt lgkmcnt(8)
    ds_read_b64_tr_b16 a[144:145], v11 offset:512
    v_mfma_f32_16x16x32_bf16 v[100:103], a[76:79], a[44:47], v[100:103]
    ds_read_b64_tr_b16 a[146:147], v11 offset:4608
    v_mfma_f32_16x16x32_bf16 v[96:99], a[80:83], a[32:35], v[52:55]
    ds_read_b64_tr_b16 a[176:177], v11 offset:8704
    v_mfma_f32_16x16x32_bf16 v[96:99], a[84:87], a[36:39], v[96:99]
    ds_read_b64_tr_b16 a[178:179], v11 offset:12800
    v_mfma_f32_16x16x32_bf16 v[96:99], a[88:91], a[40:43], v[96:99]
    ds_read_b64_tr_b16 a[148:149], v12 offset:512
    v_mfma_f32_16x16x32_bf16 v[96:99], a[92:95], a[44:47], v[96:99]
    buffer_load_dwordx4 v2, s[16:19], s28 offen offset:1024 nt lds
    v_mfma_f32_16x16x32_bf16 v[104:107], a[96:99], a[32:35], v[52:55]
    ds_read_b64_tr_b16 a[150:151], v12 offset:4608
    v_mfma_f32_16x16x32_bf16 v[104:107], a[100:103], a[36:39], v[104:107]
    ds_read_b64_tr_b16 a[180:181], v12 offset:8704
    v_mfma_f32_16x16x32_bf16 v[104:107], a[104:107], a[40:43], v[104:107]
    ds_read_b64_tr_b16 a[182:183], v12 offset:12800
    v_mfma_f32_16x16x32_bf16 v[104:107], a[108:111], a[44:47], v[104:107]
    s_waitcnt lgkmcnt(8)
    ds_read_b64_tr_b16 a[152:153], v11 offset:768
    v_mfma_f32_16x16x32_bf16 v[108:111], a[112:115], a[32:35], v[52:55]
    ds_read_b64_tr_b16 a[154:155], v11 offset:4864
    v_mfma_f32_16x16x32_bf16 v[108:111], a[116:119], a[36:39], v[108:111]
    ds_read_b64_tr_b16 a[184:185], v11 offset:8960
    v_mfma_f32_16x16x32_bf16 v[108:111], a[120:123], a[40:43], v[108:111]
    ds_read_b64_tr_b16 a[186:187], v11 offset:13056
    v_mfma_f32_16x16x32_bf16 v[108:111], a[124:127], a[44:47], v[108:111]
    ds_read_b64_tr_b16 a[156:157], v12 offset:768
    v_exp_f32 v90, v90
    v_mfma_f32_16x16x32_bf16 v[128:131], a[128:131], v[68:71], v[128:131]
    ds_read_b64_tr_b16 a[158:159], v12 offset:4864
    v_mfma_f32_16x16x32_bf16 v[128:131], a[160:163], v[72:75], v[128:131]
    buffer_load_dwordx4 v3, s[16:19], s28 offen offset:2048 nt lds
    v_smfmac_f32_16x16x64_bf16 a[228:231], a[224:227], v[68:75], v4
    ds_read_b64_tr_b16 a[188:189], v12 offset:8960
    v_mfma_f32_16x16x32_bf16 v[132:135], a[132:135], v[68:71], v[132:135]
    ds_read_b64_tr_b16 a[190:191], v12 offset:13056
    v_mfma_f32_16x16x32_bf16 v[132:135], a[164:167], v[72:75], v[132:135]
    s_waitcnt lgkmcnt(8)
    v_exp_f32 v91, v91
    v_mfma_f32_16x16x32_bf16 v[136:139], a[136:139], v[68:71], v[136:139]
    s_add_u32 s38, s35, 114688
    v_exp_f32 v92, v92
    v_mfma_f32_16x16x32_bf16 v[136:139], a[168:171], v[72:75], v[136:139]
    s_add_u32 m0, s26, s32
    v_exp_f32 v93, v93
    v_mfma_f32_16x16x32_bf16 v[140:143], a[140:143], v[68:71], v[140:143]
    v_exp_f32 v94, v94
    v_mfma_f32_16x16x32_bf16 v[140:143], a[172:175], v[72:75], v[140:143]
    v_exp_f32 v95, v95
    v_mfma_f32_16x16x32_bf16 v[144:147], a[144:147], v[68:71], v[144:147]
    v_exp_f32 v103, v103
    v_mfma_f32_16x16x32_bf16 v[144:147], a[176:179], v[72:75], v[144:147]
    v_exp_f32 v102, v102
    v_mfma_f32_16x16x32_bf16 v[148:151], a[148:151], v[68:71], v[148:151]
    s_waitcnt lgkmcnt(0)
    v_exp_f32 v101, v101
    v_mfma_f32_16x16x32_bf16 v[148:151], a[180:183], v[72:75], v[148:151]
    v_exp_f32 v100, v100
    v_mfma_f32_16x16x32_bf16 v[152:155], a[152:155], v[68:71], v[152:155]
    v_exp_f32 v99, v99
    v_mfma_f32_16x16x32_bf16 v[152:155], a[184:187], v[72:75], v[152:155]
    v_exp_f32 v98, v98
    v_mfma_f32_16x16x32_bf16 v[156:159], a[156:159], v[68:71], v[156:159]
    v_exp_f32 v97, v97
    v_mfma_f32_16x16x32_bf16 v[156:159], a[188:191], v[72:75], v[156:159]
    s_waitcnt vmcnt(14)
    s_barrier
    v_mfma_f32_16x16x32_bf16 v[116:119], a[64:67], a[48:51], v[56:59]
    v_exp_f32 v96, v96
    v_add_u32 v10, s27, v7
    v_mfma_f32_16x16x32_bf16 v[116:119], a[68:71], a[52:55], v[116:119]
    ds_read_b128 a[64:67], v10 offset:4096
    v_cvt_pk_bf16_f32 v89, v90, v91
    v_mfma_f32_16x16x32_bf16 v[116:119], a[72:75], a[56:59], v[116:119]
    ds_read_b128 a[68:71], v10 offset:4352
    v_cvt_pk_bf16_f32 v90, v92, v93
    v_mfma_f32_16x16x32_bf16 v[116:119], a[76:79], a[60:63], v[116:119]
    v_exp_f32 v104, v104
    v_mfma_f32_16x16x32_bf16 v[112:115], a[80:83], a[48:51], v[56:59]
    ds_read_b128 a[72:75], v10 offset:4608
    v_cvt_pk_bf16_f32 v91, v94, v95
    v_mfma_f32_16x16x32_bf16 v[112:115], a[84:87], a[52:55], v[112:115]
    v_exp_f32 v105, v105
    v_mfma_f32_16x16x32_bf16 v[112:115], a[88:91], a[56:59], v[112:115]
    ds_read_b128 a[76:79], v10 offset:4864
    v_add_u32 v11, s27, v8
    v_mfma_f32_16x16x32_bf16 v[112:115], a[92:95], a[60:63], v[112:115]
    v_exp_f32 v106, v106
    v_mfma_f32_16x16x32_bf16 v[120:123], a[96:99], a[48:51], v[56:59]
    ds_read_b128 a[80:83], v10 offset:0
    v_add_u32 v12, s27, v9
    v_mfma_f32_16x16x32_bf16 v[120:123], a[100:103], a[52:55], v[120:123]
    v_exp_f32 v107, v107
    v_mfma_f32_16x16x32_bf16 v[120:123], a[104:107], a[56:59], v[120:123]
    ds_read_b128 a[84:87], v10 offset:256
    v_cvt_pk_bf16_f32 v103, v102, v103
    v_mfma_f32_16x16x32_bf16 v[120:123], a[108:111], a[60:63], v[120:123]
    buffer_load_dwordx4 v2, s[8:11], s38 offen offset:0 nt lds
    v_mfma_f32_16x16x32_bf16 v[124:127], a[112:115], a[48:51], v[56:59]
    ds_read_b128 a[88:91], v10 offset:512
    v_cvt_pk_bf16_f32 v102, v100, v101
    v_mfma_f32_16x16x32_bf16 v[124:127], a[116:119], a[52:55], v[124:127]
    v_exp_f32 v108, v108
    v_mfma_f32_16x16x32_bf16 v[124:127], a[120:123], a[56:59], v[124:127]
    ds_read_b128 a[92:95], v10 offset:768
    v_cvt_pk_bf16_f32 v101, v98, v99
    v_mfma_f32_16x16x32_bf16 v[124:127], a[124:127], a[60:63], v[124:127]
    v_exp_f32 v109, v109
    v_mfma_f32_16x16x32_bf16 v[160:163], a[128:131], v[84:87], v[160:163]
    ds_read_b128 a[96:99], v10 offset:8192
    v_cvt_pk_bf16_f32 v100, v96, v97
    v_mfma_f32_16x16x32_bf16 v[160:163], a[160:163], v[88:91], v[160:163]
    buffer_load_dwordx4 v2, s[8:11], s38 offen offset:1024 nt lds
    v_smfmac_f32_16x16x64_bf16 a[232:235], a[224:227], v[84:91], v4
    v_cvt_pk_bf16_f32 v104, v104, v105
    v_mfma_f32_16x16x32_bf16 v[164:167], a[132:135], v[84:87], v[164:167]
    ds_read_b128 a[100:103], v10 offset:8448
    v_cvt_pk_bf16_f32 v105, v106, v107
    v_mfma_f32_16x16x32_bf16 v[164:167], a[164:167], v[88:91], v[164:167]
    v_exp_f32 v110, v110
    v_mfma_f32_16x16x32_bf16 v[168:171], a[136:139], v[84:87], v[168:171]
    ds_read_b128 a[104:107], v10 offset:8704
    v_cvt_pk_bf16_f32 v106, v108, v109
    v_mfma_f32_16x16x32_bf16 v[168:171], a[168:171], v[88:91], v[168:171]
    s_waitcnt lgkmcnt(3)
    v_exp_f32 v111, v111
    v_mfma_f32_16x16x32_bf16 v[172:175], a[140:143], v[84:87], v[172:175]
    ds_read_b128 a[108:111], v10 offset:8960
    v_cvt_pk_bf16_f32 v107, v110, v111
    v_mfma_f32_16x16x32_bf16 v[172:175], a[172:175], v[88:91], v[172:175]
    v_exp_f32 v119, v119
    v_mfma_f32_16x16x32_bf16 v[176:179], a[144:147], v[84:87], v[176:179]
    ds_read_b128 a[112:115], v10 offset:12288
    v_mfma_f32_16x16x32_bf16 v[176:179], a[176:179], v[88:91], v[176:179]
    v_exp_f32 v118, v118
    v_mfma_f32_16x16x32_bf16 v[180:183], a[148:151], v[84:87], v[180:183]
    ds_read_b128 a[116:119], v10 offset:12544
    v_cvt_pk_bf16_f32 v119, v118, v119
    v_mfma_f32_16x16x32_bf16 v[180:183], a[180:183], v[88:91], v[180:183]
    buffer_load_dwordx4 v3, s[8:11], s38 offen offset:2048 nt lds
    v_mfma_f32_16x16x32_bf16 v[184:187], a[152:155], v[84:87], v[184:187]
    ds_read_b128 a[120:123], v10 offset:12800
    v_mfma_f32_16x16x32_bf16 v[184:187], a[184:187], v[88:91], v[184:187]
    v_exp_f32 v117, v117
    v_mfma_f32_16x16x32_bf16 v[188:191], a[156:159], v[84:87], v[188:191]
    ds_read_b128 a[124:127], v10 offset:13056
    v_mfma_f32_16x16x32_bf16 v[188:191], a[188:191], v[88:91], v[188:191]
    v_exp_f32 v116, v116
    v_mfma_f32_16x16x32_bf16 v[68:71], a[64:67], a[0:3], v[44:47]
    v_exp_f32 v115, v115
    v_mfma_f32_16x16x32_bf16 v[68:71], a[68:71], a[4:7], v[68:71]
    v_exp_f32 v114, v114
    v_mfma_f32_16x16x32_bf16 v[68:71], a[72:75], a[8:11], v[68:71]
    v_exp_f32 v113, v113
    v_mfma_f32_16x16x32_bf16 v[68:71], a[76:79], a[12:15], v[68:71]
    v_exp_f32 v112, v112
    v_mfma_f32_16x16x32_bf16 v[64:67], a[80:83], a[0:3], v[44:47]
    v_exp_f32 v120, v120
    v_mfma_f32_16x16x32_bf16 v[64:67], a[84:87], a[4:7], v[64:67]
    v_exp_f32 v121, v121
    v_mfma_f32_16x16x32_bf16 v[64:67], a[88:91], a[8:11], v[64:67]
    s_waitcnt lgkmcnt(0)
    v_exp_f32 v122, v122
    v_mfma_f32_16x16x32_bf16 v[64:67], a[92:95], a[12:15], v[64:67]
    buffer_load_dwordx4 v3, s[8:11], s38 offen offset:3072 nt lds
    v_mfma_f32_16x16x32_bf16 v[72:75], a[96:99], a[0:3], v[44:47]
    s_add_u32 m0, s26, s33
    v_exp_f32 v123, v123
    v_mfma_f32_16x16x32_bf16 v[72:75], a[100:103], a[4:7], v[72:75]
    v_exp_f32 v124, v124
    v_mfma_f32_16x16x32_bf16 v[72:75], a[104:107], a[8:11], v[72:75]
    v_exp_f32 v125, v125
    v_mfma_f32_16x16x32_bf16 v[72:75], a[108:111], a[12:15], v[72:75]
    v_exp_f32 v126, v126
    v_mfma_f32_16x16x32_bf16 v[76:79], a[112:115], a[0:3], v[44:47]
    v_exp_f32 v127, v127
    v_mfma_f32_16x16x32_bf16 v[76:79], a[116:119], a[4:7], v[76:79]
    v_exp_f32 v71, v71
    v_mfma_f32_16x16x32_bf16 v[76:79], a[120:123], a[8:11], v[76:79]
    v_exp_f32 v70, v70
    v_mfma_f32_16x16x32_bf16 v[76:79], a[124:127], a[12:15], v[76:79]
    buffer_load_dwordx4 v2, s[12:15], s38 offen offset:0 nt lds
    v_mfma_f32_16x16x32_bf16 v[192:195], a[128:131], v[100:103], v[192:195]
    v_exp_f32 v69, v69
    v_mfma_f32_16x16x32_bf16 v[192:195], a[160:163], v[104:107], v[192:195]
    v_exp_f32 v68, v68
    v_smfmac_f32_16x16x64_bf16 a[236:239], a[224:227], v[100:107], v4
    v_cvt_pk_bf16_f32 v118, v116, v117
    v_mfma_f32_16x16x32_bf16 v[196:199], a[132:135], v[100:103], v[196:199]
    v_exp_f32 v67, v67
    v_mfma_f32_16x16x32_bf16 v[196:199], a[164:167], v[104:107], v[196:199]
    v_exp_f32 v66, v66
    v_mfma_f32_16x16x32_bf16 v[200:203], a[136:139], v[100:103], v[200:203]
    v_exp_f32 v65, v65
    v_mfma_f32_16x16x32_bf16 v[200:203], a[168:171], v[104:107], v[200:203]
    v_exp_f32 v64, v64
    v_mfma_f32_16x16x32_bf16 v[204:207], a[140:143], v[100:103], v[204:207]
    v_exp_f32 v72, v72
    v_mfma_f32_16x16x32_bf16 v[204:207], a[172:175], v[104:107], v[204:207]
    buffer_load_dwordx4 v3, s[12:15], s38 offen offset:1024 nt lds
    v_mfma_f32_16x16x32_bf16 v[208:211], a[144:147], v[100:103], v[208:211]
    v_exp_f32 v73, v73
    v_mfma_f32_16x16x32_bf16 v[208:211], a[176:179], v[104:107], v[208:211]
    v_exp_f32 v74, v74
    v_mfma_f32_16x16x32_bf16 v[212:215], a[148:151], v[100:103], v[212:215]
    v_exp_f32 v75, v75
    v_mfma_f32_16x16x32_bf16 v[212:215], a[180:183], v[104:107], v[212:215]
    v_exp_f32 v76, v76
    v_mfma_f32_16x16x32_bf16 v[216:219], a[152:155], v[100:103], v[216:219]
    v_exp_f32 v77, v77
    v_mfma_f32_16x16x32_bf16 v[216:219], a[184:187], v[104:107], v[216:219]
    v_exp_f32 v78, v78
    v_mfma_f32_16x16x32_bf16 v[220:223], a[156:159], v[100:103], v[220:223]
    v_exp_f32 v79, v79
    v_mfma_f32_16x16x32_bf16 v[220:223], a[188:191], v[104:107], v[220:223]
    v_cvt_pk_bf16_f32 v117, v114, v115
    v_cvt_pk_bf16_f32 v116, v112, v113
    v_mfma_f32_16x16x32_bf16 v[84:87], a[64:67], a[16:19], v[48:51]
    v_cvt_pk_bf16_f32 v120, v120, v121
    v_cvt_pk_bf16_f32 v121, v122, v123
    v_mfma_f32_16x16x32_bf16 v[84:87], a[68:71], a[20:23], v[84:87]
    v_cvt_pk_bf16_f32 v122, v124, v125
    v_cvt_pk_bf16_f32 v123, v126, v127
    v_mfma_f32_16x16x32_bf16 v[84:87], a[72:75], a[24:27], v[84:87]
    v_cvt_pk_bf16_f32 v71, v70, v71
    v_cvt_pk_bf16_f32 v70, v68, v69
    v_mfma_f32_16x16x32_bf16 v[84:87], a[76:79], a[28:31], v[84:87]
    buffer_load_dwordx4 v2, s[12:15], s38 offen offset:2048 nt lds
    v_mfma_f32_16x16x32_bf16 v[80:83], a[80:83], a[16:19], v[48:51]
    v_cvt_pk_bf16_f32 v69, v66, v67
    v_cvt_pk_bf16_f32 v68, v64, v65
    v_mfma_f32_16x16x32_bf16 v[80:83], a[84:87], a[20:23], v[80:83]
    v_cvt_pk_bf16_f32 v72, v72, v73
    v_cvt_pk_bf16_f32 v73, v74, v75
    v_mfma_f32_16x16x32_bf16 v[80:83], a[88:91], a[24:27], v[80:83]
    v_exp_f32 v87, v87
    v_mfma_f32_16x16x32_bf16 v[80:83], a[92:95], a[28:31], v[80:83]
    v_exp_f32 v86, v86
    v_mfma_f32_16x16x32_bf16 v[88:91], a[96:99], a[16:19], v[48:51]
    v_exp_f32 v85, v85
    v_mfma_f32_16x16x32_bf16 v[88:91], a[100:103], a[20:23], v[88:91]
    v_exp_f32 v84, v84
    v_mfma_f32_16x16x32_bf16 v[88:91], a[104:107], a[24:27], v[88:91]
    v_exp_f32 v83, v83
    v_mfma_f32_16x16x32_bf16 v[88:91], a[108:111], a[28:31], v[88:91]
    buffer_load_dwordx4 v3, s[12:15], s38 offen offset:3072 nt lds
    v_mfma_f32_16x16x32_bf16 v[92:95], a[112:115], a[16:19], v[48:51]
    s_mov_b32 m0, s58
    v_exp_f32 v82, v82
    v_mfma_f32_16x16x32_bf16 v[92:95], a[116:119], a[20:23], v[92:95]
    s_add_u32 s38, s36, 0
    v_exp_f32 v81, v81
    v_mfma_f32_16x16x32_bf16 v[92:95], a[120:123], a[24:27], v[92:95]
    v_exp_f32 v80, v80
    v_mfma_f32_16x16x32_bf16 v[92:95], a[124:127], a[28:31], v[92:95]
    v_exp_f32 v88, v88
    v_mfma_f32_16x16x32_bf16 v[224:227], a[128:131], v[116:119], v[224:227]
    ds_read_b64_tr_b16 a[128:129], v11 offset:0
    v_cvt_pk_bf16_f32 v74, v76, v77
    v_mfma_f32_16x16x32_bf16 v[224:227], a[160:163], v[120:123], v[224:227]
    ds_read_b64_tr_b16 a[130:131], v11 offset:4096
    v_cvt_pk_bf16_f32 v75, v78, v79
    v_smfmac_f32_16x16x64_bf16 a[240:243], a[224:227], v[116:123], v4
    ds_read_b64_tr_b16 a[160:161], v11 offset:8192
    v_mfma_f32_16x16x32_bf16 v[228:231], a[132:135], v[116:119], v[228:231]
    ds_read_b64_tr_b16 a[162:163], v11 offset:12288
    v_cvt_pk_bf16_f32 v87, v86, v87
    v_mfma_f32_16x16x32_bf16 v[228:231], a[164:167], v[120:123], v[228:231]
    ds_read_b64_tr_b16 a[132:133], v12 offset:0
    v_cvt_pk_bf16_f32 v86, v84, v85
    v_mfma_f32_16x16x32_bf16 v[232:235], a[136:139], v[116:119], v[232:235]
    ds_read_b64_tr_b16 a[134:135], v12 offset:4096
    v_cvt_pk_bf16_f32 v85, v82, v83
    v_mfma_f32_16x16x32_bf16 v[232:235], a[168:171], v[120:123], v[232:235]
    buffer_load_dwordx4 v3, s[16:19], s28 offen offset:3072 nt lds
    v_mfma_f32_16x16x32_bf16 v[236:239], a[140:143], v[116:119], v[236:239]
    s_mov_b32 m0, s59
    v_exp_f32 v89, v89
    v_mfma_f32_16x16x32_bf16 v[236:239], a[172:175], v[120:123], v[236:239]
    ds_read_b64_tr_b16 a[164:165], v12 offset:8192
    v_cvt_pk_bf16_f32 v84, v80, v81
    v_mfma_f32_16x16x32_bf16 v[240:243], a[144:147], v[116:119], v[240:243]
    ds_read_b64_tr_b16 a[166:167], v12 offset:12288
    v_cvt_pk_bf16_f32 v88, v88, v89
    v_mfma_f32_16x16x32_bf16 v[240:243], a[176:179], v[120:123], v[240:243]
    ds_read_b64_tr_b16 a[136:137], v11 offset:256
    v_mfma_f32_16x16x32_bf16 v[244:247], a[148:151], v[116:119], v[244:247]
    ds_read_b64_tr_b16 a[138:139], v11 offset:4352
    v_mfma_f32_16x16x32_bf16 v[244:247], a[180:183], v[120:123], v[244:247]
    ds_read_b64_tr_b16 a[168:169], v11 offset:8448
    v_mfma_f32_16x16x32_bf16 v[248:251], a[152:155], v[116:119], v[248:251]
    ds_read_b64_tr_b16 a[170:171], v11 offset:12544
    v_mfma_f32_16x16x32_bf16 v[248:251], a[184:187], v[120:123], v[248:251]
    buffer_load_dwordx4 v2, s[16:19], s29 offen offset:0 nt lds
    v_mfma_f32_16x16x32_bf16 v[252:255], a[156:159], v[116:119], v[252:255]
    ds_read_b64_tr_b16 a[140:141], v12 offset:256
    v_mfma_f32_16x16x32_bf16 v[252:255], a[188:191], v[120:123], v[252:255]
    ds_read_b64_tr_b16 a[142:143], v12 offset:4352
    v_mfma_f32_16x16x32_bf16 v[100:103], a[64:67], a[32:35], v[52:55]
    ds_read_b64_tr_b16 a[172:173], v12 offset:8448
    v_mfma_f32_16x16x32_bf16 v[100:103], a[68:71], a[36:39], v[100:103]
    ds_read_b64_tr_b16 a[174:175], v12 offset:12544
    v_mfma_f32_16x16x32_bf16 v[100:103], a[72:75], a[40:43], v[100:103]
    s_waitcnt lgkmcnt(8)
    ds_read_b64_tr_b16 a[144:145], v11 offset:512
    v_mfma_f32_16x16x32_bf16 v[100:103], a[76:79], a[44:47], v[100:103]
    ds_read_b64_tr_b16 a[146:147], v11 offset:4608
    v_mfma_f32_16x16x32_bf16 v[96:99], a[80:83], a[32:35], v[52:55]
    ds_read_b64_tr_b16 a[176:177], v11 offset:8704
    v_mfma_f32_16x16x32_bf16 v[96:99], a[84:87], a[36:39], v[96:99]
    ds_read_b64_tr_b16 a[178:179], v11 offset:12800
    v_mfma_f32_16x16x32_bf16 v[96:99], a[88:91], a[40:43], v[96:99]
    ds_read_b64_tr_b16 a[148:149], v12 offset:512
    v_mfma_f32_16x16x32_bf16 v[96:99], a[92:95], a[44:47], v[96:99]
    buffer_load_dwordx4 v2, s[16:19], s29 offen offset:1024 nt lds
    v_mfma_f32_16x16x32_bf16 v[104:107], a[96:99], a[32:35], v[52:55]
    ds_read_b64_tr_b16 a[150:151], v12 offset:4608
    v_mfma_f32_16x16x32_bf16 v[104:107], a[100:103], a[36:39], v[104:107]
    ds_read_b64_tr_b16 a[180:181], v12 offset:8704
    v_mfma_f32_16x16x32_bf16 v[104:107], a[104:107], a[40:43], v[104:107]
    ds_read_b64_tr_b16 a[182:183], v12 offset:12800
    v_mfma_f32_16x16x32_bf16 v[104:107], a[108:111], a[44:47], v[104:107]
    s_waitcnt lgkmcnt(8)
    ds_read_b64_tr_b16 a[152:153], v11 offset:768
    v_mfma_f32_16x16x32_bf16 v[108:111], a[112:115], a[32:35], v[52:55]
    ds_read_b64_tr_b16 a[154:155], v11 offset:4864
    v_mfma_f32_16x16x32_bf16 v[108:111], a[116:119], a[36:39], v[108:111]
    ds_read_b64_tr_b16 a[184:185], v11 offset:8960
    v_mfma_f32_16x16x32_bf16 v[108:111], a[120:123], a[40:43], v[108:111]
    ds_read_b64_tr_b16 a[186:187], v11 offset:13056
    v_mfma_f32_16x16x32_bf16 v[108:111], a[124:127], a[44:47], v[108:111]
    ds_read_b64_tr_b16 a[156:157], v12 offset:768
    v_exp_f32 v90, v90
    v_mfma_f32_16x16x32_bf16 v[128:131], a[128:131], v[68:71], v[128:131]
    ds_read_b64_tr_b16 a[158:159], v12 offset:4864
    v_mfma_f32_16x16x32_bf16 v[128:131], a[160:163], v[72:75], v[128:131]
    buffer_load_dwordx4 v3, s[16:19], s29 offen offset:2048 nt lds
    v_smfmac_f32_16x16x64_bf16 a[228:231], a[224:227], v[68:75], v4
    ds_read_b64_tr_b16 a[188:189], v12 offset:8960
    v_mfma_f32_16x16x32_bf16 v[132:135], a[132:135], v[68:71], v[132:135]
    ds_read_b64_tr_b16 a[190:191], v12 offset:13056
    v_mfma_f32_16x16x32_bf16 v[132:135], a[164:167], v[72:75], v[132:135]
    s_waitcnt lgkmcnt(8)
    v_exp_f32 v91, v91
    v_mfma_f32_16x16x32_bf16 v[136:139], a[136:139], v[68:71], v[136:139]
    s_add_u32 m0, s27, s32
    v_exp_f32 v92, v92
    v_mfma_f32_16x16x32_bf16 v[136:139], a[168:171], v[72:75], v[136:139]
    v_exp_f32 v93, v93
    v_mfma_f32_16x16x32_bf16 v[140:143], a[140:143], v[68:71], v[140:143]
    v_exp_f32 v94, v94
    v_mfma_f32_16x16x32_bf16 v[140:143], a[172:175], v[72:75], v[140:143]
    v_exp_f32 v95, v95
    v_mfma_f32_16x16x32_bf16 v[144:147], a[144:147], v[68:71], v[144:147]
    v_exp_f32 v103, v103
    v_mfma_f32_16x16x32_bf16 v[144:147], a[176:179], v[72:75], v[144:147]
    v_exp_f32 v102, v102
    v_mfma_f32_16x16x32_bf16 v[148:151], a[148:151], v[68:71], v[148:151]
    s_waitcnt lgkmcnt(0)
    v_exp_f32 v101, v101
    v_mfma_f32_16x16x32_bf16 v[148:151], a[180:183], v[72:75], v[148:151]
    v_exp_f32 v100, v100
    v_mfma_f32_16x16x32_bf16 v[152:155], a[152:155], v[68:71], v[152:155]
    v_exp_f32 v99, v99
    v_mfma_f32_16x16x32_bf16 v[152:155], a[184:187], v[72:75], v[152:155]
    v_exp_f32 v98, v98
    v_mfma_f32_16x16x32_bf16 v[156:159], a[156:159], v[68:71], v[156:159]
    v_exp_f32 v97, v97
    v_mfma_f32_16x16x32_bf16 v[156:159], a[188:191], v[72:75], v[156:159]
    s_waitcnt vmcnt(14)
    s_barrier
    v_mfma_f32_16x16x32_bf16 v[116:119], a[64:67], a[48:51], v[56:59]
    v_exp_f32 v96, v96
    v_add_u32 v10, s25, v7
    v_mfma_f32_16x16x32_bf16 v[116:119], a[68:71], a[52:55], v[116:119]
    ds_read_b128 a[64:67], v10 offset:4096
    v_cvt_pk_bf16_f32 v89, v90, v91
    v_mfma_f32_16x16x32_bf16 v[116:119], a[72:75], a[56:59], v[116:119]
    ds_read_b128 a[68:71], v10 offset:4352
    v_cvt_pk_bf16_f32 v90, v92, v93
    v_mfma_f32_16x16x32_bf16 v[116:119], a[76:79], a[60:63], v[116:119]
    v_exp_f32 v104, v104
    v_mfma_f32_16x16x32_bf16 v[112:115], a[80:83], a[48:51], v[56:59]
    ds_read_b128 a[72:75], v10 offset:4608
    v_cvt_pk_bf16_f32 v91, v94, v95
    v_mfma_f32_16x16x32_bf16 v[112:115], a[84:87], a[52:55], v[112:115]
    v_exp_f32 v105, v105
    v_mfma_f32_16x16x32_bf16 v[112:115], a[88:91], a[56:59], v[112:115]
    ds_read_b128 a[76:79], v10 offset:4864
    v_add_u32 v11, s25, v8
    v_mfma_f32_16x16x32_bf16 v[112:115], a[92:95], a[60:63], v[112:115]
    v_exp_f32 v106, v106
    v_mfma_f32_16x16x32_bf16 v[120:123], a[96:99], a[48:51], v[56:59]
    ds_read_b128 a[80:83], v10 offset:0
    v_add_u32 v12, s25, v9
    v_mfma_f32_16x16x32_bf16 v[120:123], a[100:103], a[52:55], v[120:123]
    v_exp_f32 v107, v107
    v_mfma_f32_16x16x32_bf16 v[120:123], a[104:107], a[56:59], v[120:123]
    ds_read_b128 a[84:87], v10 offset:256
    v_cvt_pk_bf16_f32 v103, v102, v103
    v_mfma_f32_16x16x32_bf16 v[120:123], a[108:111], a[60:63], v[120:123]
    buffer_load_dwordx4 v2, s[8:11], s38 offen offset:0 nt lds
    v_mfma_f32_16x16x32_bf16 v[124:127], a[112:115], a[48:51], v[56:59]
    ds_read_b128 a[88:91], v10 offset:512
    v_cvt_pk_bf16_f32 v102, v100, v101
    v_mfma_f32_16x16x32_bf16 v[124:127], a[116:119], a[52:55], v[124:127]
    v_exp_f32 v108, v108
    v_mfma_f32_16x16x32_bf16 v[124:127], a[120:123], a[56:59], v[124:127]
    ds_read_b128 a[92:95], v10 offset:768
    v_cvt_pk_bf16_f32 v101, v98, v99
    v_mfma_f32_16x16x32_bf16 v[124:127], a[124:127], a[60:63], v[124:127]
    v_exp_f32 v109, v109
    v_mfma_f32_16x16x32_bf16 v[160:163], a[128:131], v[84:87], v[160:163]
    ds_read_b128 a[96:99], v10 offset:8192
    v_cvt_pk_bf16_f32 v100, v96, v97
    v_mfma_f32_16x16x32_bf16 v[160:163], a[160:163], v[88:91], v[160:163]
    buffer_load_dwordx4 v2, s[8:11], s38 offen offset:1024 nt lds
    v_smfmac_f32_16x16x64_bf16 a[232:235], a[224:227], v[84:91], v4
    v_cvt_pk_bf16_f32 v104, v104, v105
    v_mfma_f32_16x16x32_bf16 v[164:167], a[132:135], v[84:87], v[164:167]
    ds_read_b128 a[100:103], v10 offset:8448
    v_cvt_pk_bf16_f32 v105, v106, v107
    v_mfma_f32_16x16x32_bf16 v[164:167], a[164:167], v[88:91], v[164:167]
    v_exp_f32 v110, v110
    v_mfma_f32_16x16x32_bf16 v[168:171], a[136:139], v[84:87], v[168:171]
    ds_read_b128 a[104:107], v10 offset:8704
    v_cvt_pk_bf16_f32 v106, v108, v109
    v_mfma_f32_16x16x32_bf16 v[168:171], a[168:171], v[88:91], v[168:171]
    s_waitcnt lgkmcnt(3)
    v_exp_f32 v111, v111
    v_mfma_f32_16x16x32_bf16 v[172:175], a[140:143], v[84:87], v[172:175]
    ds_read_b128 a[108:111], v10 offset:8960
    v_cvt_pk_bf16_f32 v107, v110, v111
    v_mfma_f32_16x16x32_bf16 v[172:175], a[172:175], v[88:91], v[172:175]
    v_exp_f32 v119, v119
    v_mfma_f32_16x16x32_bf16 v[176:179], a[144:147], v[84:87], v[176:179]
    ds_read_b128 a[112:115], v10 offset:12288
    v_mfma_f32_16x16x32_bf16 v[176:179], a[176:179], v[88:91], v[176:179]
    v_exp_f32 v118, v118
    v_mfma_f32_16x16x32_bf16 v[180:183], a[148:151], v[84:87], v[180:183]
    ds_read_b128 a[116:119], v10 offset:12544
    v_cvt_pk_bf16_f32 v119, v118, v119
    v_mfma_f32_16x16x32_bf16 v[180:183], a[180:183], v[88:91], v[180:183]
    buffer_load_dwordx4 v3, s[8:11], s38 offen offset:2048 nt lds
    v_mfma_f32_16x16x32_bf16 v[184:187], a[152:155], v[84:87], v[184:187]
    ds_read_b128 a[120:123], v10 offset:12800
    v_mfma_f32_16x16x32_bf16 v[184:187], a[184:187], v[88:91], v[184:187]
    v_exp_f32 v117, v117
    v_mfma_f32_16x16x32_bf16 v[188:191], a[156:159], v[84:87], v[188:191]
    ds_read_b128 a[124:127], v10 offset:13056
    v_mfma_f32_16x16x32_bf16 v[188:191], a[188:191], v[88:91], v[188:191]
    v_exp_f32 v116, v116
    v_mfma_f32_16x16x32_bf16 v[68:71], a[64:67], a[0:3], v[44:47]
    v_exp_f32 v115, v115
    v_mfma_f32_16x16x32_bf16 v[68:71], a[68:71], a[4:7], v[68:71]
    v_exp_f32 v114, v114
    v_mfma_f32_16x16x32_bf16 v[68:71], a[72:75], a[8:11], v[68:71]
    v_exp_f32 v113, v113
    v_mfma_f32_16x16x32_bf16 v[68:71], a[76:79], a[12:15], v[68:71]
    v_exp_f32 v112, v112
    v_mfma_f32_16x16x32_bf16 v[64:67], a[80:83], a[0:3], v[44:47]
    v_exp_f32 v120, v120
    v_mfma_f32_16x16x32_bf16 v[64:67], a[84:87], a[4:7], v[64:67]
    v_exp_f32 v121, v121
    v_mfma_f32_16x16x32_bf16 v[64:67], a[88:91], a[8:11], v[64:67]
    s_waitcnt lgkmcnt(0)
    v_exp_f32 v122, v122
    v_mfma_f32_16x16x32_bf16 v[64:67], a[92:95], a[12:15], v[64:67]
    buffer_load_dwordx4 v3, s[8:11], s38 offen offset:3072 nt lds
    v_mfma_f32_16x16x32_bf16 v[72:75], a[96:99], a[0:3], v[44:47]
    s_add_u32 m0, s27, s33
    v_exp_f32 v123, v123
    v_mfma_f32_16x16x32_bf16 v[72:75], a[100:103], a[4:7], v[72:75]
    v_exp_f32 v124, v124
    v_mfma_f32_16x16x32_bf16 v[72:75], a[104:107], a[8:11], v[72:75]
    v_exp_f32 v125, v125
    v_mfma_f32_16x16x32_bf16 v[72:75], a[108:111], a[12:15], v[72:75]
    v_exp_f32 v126, v126
    v_mfma_f32_16x16x32_bf16 v[76:79], a[112:115], a[0:3], v[44:47]
    v_exp_f32 v127, v127
    v_mfma_f32_16x16x32_bf16 v[76:79], a[116:119], a[4:7], v[76:79]
    v_exp_f32 v71, v71
    v_mfma_f32_16x16x32_bf16 v[76:79], a[120:123], a[8:11], v[76:79]
    v_exp_f32 v70, v70
    v_mfma_f32_16x16x32_bf16 v[76:79], a[124:127], a[12:15], v[76:79]
    buffer_load_dwordx4 v2, s[12:15], s38 offen offset:0 nt lds
    v_mfma_f32_16x16x32_bf16 v[192:195], a[128:131], v[100:103], v[192:195]
    v_exp_f32 v69, v69
    v_mfma_f32_16x16x32_bf16 v[192:195], a[160:163], v[104:107], v[192:195]
    v_exp_f32 v68, v68
    v_smfmac_f32_16x16x64_bf16 a[236:239], a[224:227], v[100:107], v4
    v_cvt_pk_bf16_f32 v118, v116, v117
    v_mfma_f32_16x16x32_bf16 v[196:199], a[132:135], v[100:103], v[196:199]
    v_exp_f32 v67, v67
    v_mfma_f32_16x16x32_bf16 v[196:199], a[164:167], v[104:107], v[196:199]
    v_exp_f32 v66, v66
    v_mfma_f32_16x16x32_bf16 v[200:203], a[136:139], v[100:103], v[200:203]
    v_exp_f32 v65, v65
    v_mfma_f32_16x16x32_bf16 v[200:203], a[168:171], v[104:107], v[200:203]
    v_exp_f32 v64, v64
    v_mfma_f32_16x16x32_bf16 v[204:207], a[140:143], v[100:103], v[204:207]
    v_exp_f32 v72, v72
    v_mfma_f32_16x16x32_bf16 v[204:207], a[172:175], v[104:107], v[204:207]
    buffer_load_dwordx4 v3, s[12:15], s38 offen offset:1024 nt lds
    v_mfma_f32_16x16x32_bf16 v[208:211], a[144:147], v[100:103], v[208:211]
    v_exp_f32 v73, v73
    v_mfma_f32_16x16x32_bf16 v[208:211], a[176:179], v[104:107], v[208:211]
    v_exp_f32 v74, v74
    v_mfma_f32_16x16x32_bf16 v[212:215], a[148:151], v[100:103], v[212:215]
    v_exp_f32 v75, v75
    v_mfma_f32_16x16x32_bf16 v[212:215], a[180:183], v[104:107], v[212:215]
    v_exp_f32 v76, v76
    v_mfma_f32_16x16x32_bf16 v[216:219], a[152:155], v[100:103], v[216:219]
    v_exp_f32 v77, v77
    v_mfma_f32_16x16x32_bf16 v[216:219], a[184:187], v[104:107], v[216:219]
    v_exp_f32 v78, v78
    v_mfma_f32_16x16x32_bf16 v[220:223], a[156:159], v[100:103], v[220:223]
    v_exp_f32 v79, v79
    v_mfma_f32_16x16x32_bf16 v[220:223], a[188:191], v[104:107], v[220:223]
    v_cvt_pk_bf16_f32 v117, v114, v115
    v_cvt_pk_bf16_f32 v116, v112, v113
    v_mfma_f32_16x16x32_bf16 v[84:87], a[64:67], a[16:19], v[48:51]
    v_cvt_pk_bf16_f32 v120, v120, v121
    v_cvt_pk_bf16_f32 v121, v122, v123
    v_mfma_f32_16x16x32_bf16 v[84:87], a[68:71], a[20:23], v[84:87]
    v_cvt_pk_bf16_f32 v122, v124, v125
    v_cvt_pk_bf16_f32 v123, v126, v127
    v_mfma_f32_16x16x32_bf16 v[84:87], a[72:75], a[24:27], v[84:87]
    v_cvt_pk_bf16_f32 v71, v70, v71
    v_cvt_pk_bf16_f32 v70, v68, v69
    v_mfma_f32_16x16x32_bf16 v[84:87], a[76:79], a[28:31], v[84:87]
    buffer_load_dwordx4 v2, s[12:15], s38 offen offset:2048 nt lds
    v_mfma_f32_16x16x32_bf16 v[80:83], a[80:83], a[16:19], v[48:51]
    v_cvt_pk_bf16_f32 v69, v66, v67
    v_cvt_pk_bf16_f32 v68, v64, v65
    v_mfma_f32_16x16x32_bf16 v[80:83], a[84:87], a[20:23], v[80:83]
    v_cvt_pk_bf16_f32 v72, v72, v73
    v_cvt_pk_bf16_f32 v73, v74, v75
    v_mfma_f32_16x16x32_bf16 v[80:83], a[88:91], a[24:27], v[80:83]
    v_exp_f32 v87, v87
    v_mfma_f32_16x16x32_bf16 v[80:83], a[92:95], a[28:31], v[80:83]
    v_exp_f32 v86, v86
    v_mfma_f32_16x16x32_bf16 v[88:91], a[96:99], a[16:19], v[48:51]
    v_exp_f32 v85, v85
    v_mfma_f32_16x16x32_bf16 v[88:91], a[100:103], a[20:23], v[88:91]
    v_exp_f32 v84, v84
    v_mfma_f32_16x16x32_bf16 v[88:91], a[104:107], a[24:27], v[88:91]
    v_exp_f32 v83, v83
    v_mfma_f32_16x16x32_bf16 v[88:91], a[108:111], a[28:31], v[88:91]
    buffer_load_dwordx4 v3, s[12:15], s38 offen offset:3072 nt lds
    v_mfma_f32_16x16x32_bf16 v[92:95], a[112:115], a[16:19], v[48:51]
    s_mov_b32 m0, s59
    v_exp_f32 v82, v82
    v_mfma_f32_16x16x32_bf16 v[92:95], a[116:119], a[20:23], v[92:95]
    s_add_u32 s38, s36, 16384
    v_exp_f32 v81, v81
    v_mfma_f32_16x16x32_bf16 v[92:95], a[120:123], a[24:27], v[92:95]
    v_exp_f32 v80, v80
    v_mfma_f32_16x16x32_bf16 v[92:95], a[124:127], a[28:31], v[92:95]
    v_exp_f32 v88, v88
    v_mfma_f32_16x16x32_bf16 v[224:227], a[128:131], v[116:119], v[224:227]
    ds_read_b64_tr_b16 a[128:129], v11 offset:0
    v_cvt_pk_bf16_f32 v74, v76, v77
    v_mfma_f32_16x16x32_bf16 v[224:227], a[160:163], v[120:123], v[224:227]
    ds_read_b64_tr_b16 a[130:131], v11 offset:4096
    v_cvt_pk_bf16_f32 v75, v78, v79
    v_smfmac_f32_16x16x64_bf16 a[240:243], a[224:227], v[116:123], v4
    ds_read_b64_tr_b16 a[160:161], v11 offset:8192
    v_mfma_f32_16x16x32_bf16 v[228:231], a[132:135], v[116:119], v[228:231]
    ds_read_b64_tr_b16 a[162:163], v11 offset:12288
    v_cvt_pk_bf16_f32 v87, v86, v87
    v_mfma_f32_16x16x32_bf16 v[228:231], a[164:167], v[120:123], v[228:231]
    ds_read_b64_tr_b16 a[132:133], v12 offset:0
    v_cvt_pk_bf16_f32 v86, v84, v85
    v_mfma_f32_16x16x32_bf16 v[232:235], a[136:139], v[116:119], v[232:235]
    ds_read_b64_tr_b16 a[134:135], v12 offset:4096
    v_cvt_pk_bf16_f32 v85, v82, v83
    v_mfma_f32_16x16x32_bf16 v[232:235], a[168:171], v[120:123], v[232:235]
    buffer_load_dwordx4 v3, s[16:19], s29 offen offset:3072 nt lds
    v_mfma_f32_16x16x32_bf16 v[236:239], a[140:143], v[116:119], v[236:239]
    s_mov_b32 m0, s60
    v_exp_f32 v89, v89
    v_mfma_f32_16x16x32_bf16 v[236:239], a[172:175], v[120:123], v[236:239]
    ds_read_b64_tr_b16 a[164:165], v12 offset:8192
    v_cvt_pk_bf16_f32 v84, v80, v81
    v_mfma_f32_16x16x32_bf16 v[240:243], a[144:147], v[116:119], v[240:243]
    ds_read_b64_tr_b16 a[166:167], v12 offset:12288
    v_cvt_pk_bf16_f32 v88, v88, v89
    v_mfma_f32_16x16x32_bf16 v[240:243], a[176:179], v[120:123], v[240:243]
    ds_read_b64_tr_b16 a[136:137], v11 offset:256
    v_mfma_f32_16x16x32_bf16 v[244:247], a[148:151], v[116:119], v[244:247]
    ds_read_b64_tr_b16 a[138:139], v11 offset:4352
    v_mfma_f32_16x16x32_bf16 v[244:247], a[180:183], v[120:123], v[244:247]
    ds_read_b64_tr_b16 a[168:169], v11 offset:8448
    v_mfma_f32_16x16x32_bf16 v[248:251], a[152:155], v[116:119], v[248:251]
    ds_read_b64_tr_b16 a[170:171], v11 offset:12544
    v_mfma_f32_16x16x32_bf16 v[248:251], a[184:187], v[120:123], v[248:251]
    buffer_load_dwordx4 v2, s[16:19], s30 offen offset:0 nt lds
    v_mfma_f32_16x16x32_bf16 v[252:255], a[156:159], v[116:119], v[252:255]
    ds_read_b64_tr_b16 a[140:141], v12 offset:256
    v_mfma_f32_16x16x32_bf16 v[252:255], a[188:191], v[120:123], v[252:255]
    ds_read_b64_tr_b16 a[142:143], v12 offset:4352
    v_mfma_f32_16x16x32_bf16 v[100:103], a[64:67], a[32:35], v[52:55]
    ds_read_b64_tr_b16 a[172:173], v12 offset:8448
    v_mfma_f32_16x16x32_bf16 v[100:103], a[68:71], a[36:39], v[100:103]
    ds_read_b64_tr_b16 a[174:175], v12 offset:12544
    v_mfma_f32_16x16x32_bf16 v[100:103], a[72:75], a[40:43], v[100:103]
    s_waitcnt lgkmcnt(8)
    ds_read_b64_tr_b16 a[144:145], v11 offset:512
    v_mfma_f32_16x16x32_bf16 v[100:103], a[76:79], a[44:47], v[100:103]
    ds_read_b64_tr_b16 a[146:147], v11 offset:4608
    v_mfma_f32_16x16x32_bf16 v[96:99], a[80:83], a[32:35], v[52:55]
    ds_read_b64_tr_b16 a[176:177], v11 offset:8704
    v_mfma_f32_16x16x32_bf16 v[96:99], a[84:87], a[36:39], v[96:99]
    ds_read_b64_tr_b16 a[178:179], v11 offset:12800
    v_mfma_f32_16x16x32_bf16 v[96:99], a[88:91], a[40:43], v[96:99]
    ds_read_b64_tr_b16 a[148:149], v12 offset:512
    v_mfma_f32_16x16x32_bf16 v[96:99], a[92:95], a[44:47], v[96:99]
    buffer_load_dwordx4 v2, s[16:19], s30 offen offset:1024 nt lds
    v_mfma_f32_16x16x32_bf16 v[104:107], a[96:99], a[32:35], v[52:55]
    ds_read_b64_tr_b16 a[150:151], v12 offset:4608
    v_mfma_f32_16x16x32_bf16 v[104:107], a[100:103], a[36:39], v[104:107]
    ds_read_b64_tr_b16 a[180:181], v12 offset:8704
    v_mfma_f32_16x16x32_bf16 v[104:107], a[104:107], a[40:43], v[104:107]
    ds_read_b64_tr_b16 a[182:183], v12 offset:12800
    v_mfma_f32_16x16x32_bf16 v[104:107], a[108:111], a[44:47], v[104:107]
    s_waitcnt lgkmcnt(8)
    ds_read_b64_tr_b16 a[152:153], v11 offset:768
    v_mfma_f32_16x16x32_bf16 v[108:111], a[112:115], a[32:35], v[52:55]
    ds_read_b64_tr_b16 a[154:155], v11 offset:4864
    v_mfma_f32_16x16x32_bf16 v[108:111], a[116:119], a[36:39], v[108:111]
    ds_read_b64_tr_b16 a[184:185], v11 offset:8960
    v_mfma_f32_16x16x32_bf16 v[108:111], a[120:123], a[40:43], v[108:111]
    ds_read_b64_tr_b16 a[186:187], v11 offset:13056
    v_mfma_f32_16x16x32_bf16 v[108:111], a[124:127], a[44:47], v[108:111]
    ds_read_b64_tr_b16 a[156:157], v12 offset:768
    v_exp_f32 v90, v90
    v_mfma_f32_16x16x32_bf16 v[128:131], a[128:131], v[68:71], v[128:131]
    ds_read_b64_tr_b16 a[158:159], v12 offset:4864
    v_mfma_f32_16x16x32_bf16 v[128:131], a[160:163], v[72:75], v[128:131]
    buffer_load_dwordx4 v3, s[16:19], s30 offen offset:2048 nt lds
    v_smfmac_f32_16x16x64_bf16 a[228:231], a[224:227], v[68:75], v4
    ds_read_b64_tr_b16 a[188:189], v12 offset:8960
    v_mfma_f32_16x16x32_bf16 v[132:135], a[132:135], v[68:71], v[132:135]
    ds_read_b64_tr_b16 a[190:191], v12 offset:13056
    v_mfma_f32_16x16x32_bf16 v[132:135], a[164:167], v[72:75], v[132:135]
    s_waitcnt lgkmcnt(8)
    v_exp_f32 v91, v91
    v_mfma_f32_16x16x32_bf16 v[136:139], a[136:139], v[68:71], v[136:139]
    s_mov_b32 m0, s60
    v_exp_f32 v92, v92
    v_mfma_f32_16x16x32_bf16 v[136:139], a[168:171], v[72:75], v[136:139]
    v_exp_f32 v93, v93
    v_mfma_f32_16x16x32_bf16 v[140:143], a[140:143], v[68:71], v[140:143]
    v_exp_f32 v94, v94
    v_mfma_f32_16x16x32_bf16 v[140:143], a[172:175], v[72:75], v[140:143]
    v_exp_f32 v95, v95
    v_mfma_f32_16x16x32_bf16 v[144:147], a[144:147], v[68:71], v[144:147]
    v_exp_f32 v103, v103
    v_mfma_f32_16x16x32_bf16 v[144:147], a[176:179], v[72:75], v[144:147]
    v_exp_f32 v102, v102
    v_mfma_f32_16x16x32_bf16 v[148:151], a[148:151], v[68:71], v[148:151]
    s_waitcnt lgkmcnt(0)
    v_exp_f32 v101, v101
    v_mfma_f32_16x16x32_bf16 v[148:151], a[180:183], v[72:75], v[148:151]
    v_exp_f32 v100, v100
    v_mfma_f32_16x16x32_bf16 v[152:155], a[152:155], v[68:71], v[152:155]
    v_exp_f32 v99, v99
    v_mfma_f32_16x16x32_bf16 v[152:155], a[184:187], v[72:75], v[152:155]
    v_exp_f32 v98, v98
    v_mfma_f32_16x16x32_bf16 v[156:159], a[156:159], v[68:71], v[156:159]
    v_exp_f32 v97, v97
    v_mfma_f32_16x16x32_bf16 v[156:159], a[188:191], v[72:75], v[156:159]
    s_waitcnt vmcnt(16)
    s_barrier
    v_mfma_f32_16x16x32_bf16 v[116:119], a[64:67], a[48:51], v[56:59]
    v_exp_f32 v96, v96
    v_add_u32 v10, s26, v7
    v_mfma_f32_16x16x32_bf16 v[116:119], a[68:71], a[52:55], v[116:119]
    ds_read_b128 a[64:67], v10 offset:4096
    v_cvt_pk_bf16_f32 v89, v90, v91
    v_mfma_f32_16x16x32_bf16 v[116:119], a[72:75], a[56:59], v[116:119]
    ds_read_b128 a[68:71], v10 offset:4352
    v_cvt_pk_bf16_f32 v90, v92, v93
    v_mfma_f32_16x16x32_bf16 v[116:119], a[76:79], a[60:63], v[116:119]
    v_exp_f32 v104, v104
    v_mfma_f32_16x16x32_bf16 v[112:115], a[80:83], a[48:51], v[56:59]
    ds_read_b128 a[72:75], v10 offset:4608
    v_cvt_pk_bf16_f32 v91, v94, v95
    v_mfma_f32_16x16x32_bf16 v[112:115], a[84:87], a[52:55], v[112:115]
    v_exp_f32 v105, v105
    v_mfma_f32_16x16x32_bf16 v[112:115], a[88:91], a[56:59], v[112:115]
    ds_read_b128 a[76:79], v10 offset:4864
    v_add_u32 v11, s26, v8
    v_mfma_f32_16x16x32_bf16 v[112:115], a[92:95], a[60:63], v[112:115]
    v_exp_f32 v106, v106
    v_mfma_f32_16x16x32_bf16 v[120:123], a[96:99], a[48:51], v[56:59]
    ds_read_b128 a[80:83], v10 offset:0
    v_add_u32 v12, s26, v9
    v_mfma_f32_16x16x32_bf16 v[120:123], a[100:103], a[52:55], v[120:123]
    v_exp_f32 v107, v107
    v_mfma_f32_16x16x32_bf16 v[120:123], a[104:107], a[56:59], v[120:123]
    ds_read_b128 a[84:87], v10 offset:256
    v_cvt_pk_bf16_f32 v103, v102, v103
    v_mfma_f32_16x16x32_bf16 v[120:123], a[108:111], a[60:63], v[120:123]
    buffer_load_dwordx4 v3, s[16:19], s30 offen offset:3072 nt lds
    v_mfma_f32_16x16x32_bf16 v[124:127], a[112:115], a[48:51], v[56:59]
    s_mov_b32 m0, s61
    v_exp_f32 v108, v108
    v_mfma_f32_16x16x32_bf16 v[124:127], a[116:119], a[52:55], v[124:127]
    ds_read_b128 a[88:91], v10 offset:512
    v_cvt_pk_bf16_f32 v102, v100, v101
    v_mfma_f32_16x16x32_bf16 v[124:127], a[120:123], a[56:59], v[124:127]
    ds_read_b128 a[92:95], v10 offset:768
    v_cvt_pk_bf16_f32 v101, v98, v99
    v_mfma_f32_16x16x32_bf16 v[124:127], a[124:127], a[60:63], v[124:127]
    v_exp_f32 v109, v109
    v_mfma_f32_16x16x32_bf16 v[160:163], a[128:131], v[84:87], v[160:163]
    ds_read_b128 a[96:99], v10 offset:8192
    v_cvt_pk_bf16_f32 v100, v96, v97
    v_mfma_f32_16x16x32_bf16 v[160:163], a[160:163], v[88:91], v[160:163]
    buffer_load_dwordx4 v2, s[16:19], s31 offen offset:0 nt lds
    v_smfmac_f32_16x16x64_bf16 a[232:235], a[224:227], v[84:91], v4
    v_cvt_pk_bf16_f32 v104, v104, v105
    v_mfma_f32_16x16x32_bf16 v[164:167], a[132:135], v[84:87], v[164:167]
    ds_read_b128 a[100:103], v10 offset:8448
    v_cvt_pk_bf16_f32 v105, v106, v107
    v_mfma_f32_16x16x32_bf16 v[164:167], a[164:167], v[88:91], v[164:167]
    v_exp_f32 v110, v110
    v_mfma_f32_16x16x32_bf16 v[168:171], a[136:139], v[84:87], v[168:171]
    ds_read_b128 a[104:107], v10 offset:8704
    v_cvt_pk_bf16_f32 v106, v108, v109
    v_mfma_f32_16x16x32_bf16 v[168:171], a[168:171], v[88:91], v[168:171]
    s_waitcnt lgkmcnt(3)
    v_exp_f32 v111, v111
    v_mfma_f32_16x16x32_bf16 v[172:175], a[140:143], v[84:87], v[172:175]
    ds_read_b128 a[108:111], v10 offset:8960
    v_cvt_pk_bf16_f32 v107, v110, v111
    v_mfma_f32_16x16x32_bf16 v[172:175], a[172:175], v[88:91], v[172:175]
    v_exp_f32 v119, v119
    v_mfma_f32_16x16x32_bf16 v[176:179], a[144:147], v[84:87], v[176:179]
    ds_read_b128 a[112:115], v10 offset:12288
    v_mfma_f32_16x16x32_bf16 v[176:179], a[176:179], v[88:91], v[176:179]
    buffer_load_dwordx4 v2, s[16:19], s31 offen offset:1024 nt lds
    v_mfma_f32_16x16x32_bf16 v[180:183], a[148:151], v[84:87], v[180:183]
    ds_read_b128 a[116:119], v10 offset:12544
    v_mfma_f32_16x16x32_bf16 v[180:183], a[180:183], v[88:91], v[180:183]
    v_exp_f32 v118, v118
    v_mfma_f32_16x16x32_bf16 v[184:187], a[152:155], v[84:87], v[184:187]
    ds_read_b128 a[120:123], v10 offset:12800
    v_cvt_pk_bf16_f32 v119, v118, v119
    v_mfma_f32_16x16x32_bf16 v[184:187], a[184:187], v[88:91], v[184:187]
    v_exp_f32 v117, v117
    v_mfma_f32_16x16x32_bf16 v[188:191], a[156:159], v[84:87], v[188:191]
    ds_read_b128 a[124:127], v10 offset:13056
    v_mfma_f32_16x16x32_bf16 v[188:191], a[188:191], v[88:91], v[188:191]
    s_cmp_eq_u32 s40, 2
    s_cbranch_scc1 L_E
    v_mfma_f32_16x16x32_bf16 v[68:71], a[64:67], a[0:3], v[44:47]
    s_waitcnt vmcnt(18)
    v_exp_f32 v116, v116
    v_mfma_f32_16x16x32_bf16 v[68:71], a[68:71], a[4:7], v[68:71]
    s_add_u32 s40, s40, 1
    v_exp_f32 v115, v115
    v_mfma_f32_16x16x32_bf16 v[68:71], a[72:75], a[8:11], v[68:71]
    v_exp_f32 v114, v114
    v_mfma_f32_16x16x32_bf16 v[68:71], a[76:79], a[12:15], v[68:71]
    buffer_load_dwordx4 v3, s[16:19], s31 offen offset:2048 nt lds
    v_mfma_f32_16x16x32_bf16 v[64:67], a[80:83], a[0:3], v[44:47]
    ds_read_b64 a[216:217], v13 offset:8
    v_cvt_pk_bf16_f32 v118, v116, v117
    v_mfma_f32_16x16x32_bf16 v[64:67], a[84:87], a[4:7], v[64:67]
    ds_read_b64 a[218:219], v13 offset:8
    v_cvt_pk_bf16_f32 v117, v114, v115
    v_mfma_f32_16x16x32_bf16 v[64:67], a[88:91], a[8:11], v[64:67]
    s_waitcnt lgkmcnt(2)
    v_exp_f32 v113, v113
    v_mfma_f32_16x16x32_bf16 v[64:67], a[92:95], a[12:15], v[64:67]
    ds_read_b64 a[220:221], v13 offset:264
    v_exp_f32 v112, v112
    v_mfma_f32_16x16x32_bf16 v[72:75], a[96:99], a[0:3], v[44:47]
    ds_read_b64 a[222:223], v13 offset:264
    v_cvt_pk_bf16_f32 v116, v112, v113
    v_mfma_f32_16x16x32_bf16 v[72:75], a[100:103], a[4:7], v[72:75]
    ds_read_b64 a[248:249], v13 offset:520
    v_mfma_f32_16x16x32_bf16 v[72:75], a[104:107], a[8:11], v[72:75]
    ds_read_b64 a[250:251], v13 offset:520
    v_mfma_f32_16x16x32_bf16 v[72:75], a[108:111], a[12:15], v[72:75]
    buffer_load_dwordx4 v3, s[16:19], s31 offen offset:3072 nt lds
    v_mfma_f32_16x16x32_bf16 v[76:79], a[112:115], a[0:3], v[44:47]
    s_add_u32 m0, s25, s32
    v_exp_f32 v120, v120
    v_mfma_f32_16x16x32_bf16 v[76:79], a[116:119], a[4:7], v[76:79]
    ds_read_b64 a[252:253], v13 offset:776
    v_mfma_f32_16x16x32_bf16 v[76:79], a[120:123], a[8:11], v[76:79]
    ds_read_b64 a[254:255], v13 offset:776
    v_mfma_f32_16x16x32_bf16 v[76:79], a[124:127], a[12:15], v[76:79]
    ds_read_b64 a[0:1], v13 offset:0
    v_exp_f32 v121, v121
    v_mfma_f32_16x16x32_bf16 v[192:195], a[128:131], v[100:103], v[192:195]
    ds_read_b64 a[2:3], v13 offset:0
    v_cvt_pk_bf16_f32 v120, v120, v121
    v_mfma_f32_16x16x32_bf16 v[192:195], a[160:163], v[104:107], v[192:195]
    ds_read_b64 a[4:5], v13 offset:256
    v_smfmac_f32_16x16x64_bf16 a[236:239], a[224:227], v[100:107], v4
    ds_read_b64 a[6:7], v13 offset:256
    v_mfma_f32_16x16x32_bf16 v[196:199], a[132:135], v[100:103], v[196:199]
    ds_read_b64 a[8:9], v13 offset:512
    v_mfma_f32_16x16x32_bf16 v[196:199], a[164:167], v[104:107], v[196:199]
    buffer_load_dwordx4 v2, s[8:11], s38 offen offset:0 nt lds
    v_mfma_f32_16x16x32_bf16 v[200:203], a[136:139], v[100:103], v[200:203]
    ds_read_b64 a[10:11], v13 offset:512
    v_mfma_f32_16x16x32_bf16 v[200:203], a[168:171], v[104:107], v[200:203]
    ds_read_b64 a[12:13], v13 offset:768
    v_exp_f32 v122, v122
    v_mfma_f32_16x16x32_bf16 v[204:207], a[140:143], v[100:103], v[204:207]
    ds_read_b64 a[14:15], v13 offset:768
    v_mfma_f32_16x16x32_bf16 v[204:207], a[172:175], v[104:107], v[204:207]
    s_add_u32 s16, s4, s48
    s_addc_u32 s17, s5, 0
    v_exp_f32 v123, v123
    v_mfma_f32_16x16x32_bf16 v[208:211], a[144:147], v[100:103], v[208:211]
    s_mov_b32 s18, s52
    v_exp_f32 v124, v124
    v_mfma_f32_16x16x32_bf16 v[208:211], a[176:179], v[104:107], v[208:211]
    s_mov_b32 s46, s47
    v_exp_f32 v125, v125
    v_mfma_f32_16x16x32_bf16 v[212:215], a[148:151], v[100:103], v[212:215]
    s_mov_b32 s47, s48
    v_exp_f32 v126, v126
    v_mfma_f32_16x16x32_bf16 v[212:215], a[180:183], v[104:107], v[212:215]
    s_mov_b32 s48, s49
    v_exp_f32 v127, v127
    v_mfma_f32_16x16x32_bf16 v[216:219], a[152:155], v[100:103], v[216:219]
    s_mov_b32 s50, s51
    v_exp_f32 v71, v71
    v_mfma_f32_16x16x32_bf16 v[216:219], a[184:187], v[104:107], v[216:219]
    buffer_load_dwordx4 v2, s[8:11], s38 offen offset:1024 nt lds
    v_mfma_f32_16x16x32_bf16 v[220:223], a[156:159], v[100:103], v[220:223]
    s_waitcnt lgkmcnt(0)
    v_exp_f32 v70, v70
    v_mfma_f32_16x16x32_bf16 v[220:223], a[188:191], v[104:107], v[220:223]
    s_mov_b32 s51, s52
    v_exp_f32 v69, v69
    v_mfma_f32_16x16x32_bf16 v[84:87], a[64:67], a[16:19], v[48:51]
    s_mov_b32 s52, s53
    v_exp_f32 v68, v68
    v_mfma_f32_16x16x32_bf16 v[84:87], a[68:71], a[20:23], v[84:87]
    v_exp_f32 v67, v67
    v_mfma_f32_16x16x32_bf16 v[84:87], a[72:75], a[24:27], v[84:87]
    v_exp_f32 v66, v66
    v_mfma_f32_16x16x32_bf16 v[84:87], a[76:79], a[28:31], v[84:87]
    v_exp_f32 v65, v65
    v_mfma_f32_16x16x32_bf16 v[80:83], a[80:83], a[16:19], v[48:51]
    v_exp_f32 v64, v64
    v_mfma_f32_16x16x32_bf16 v[80:83], a[84:87], a[20:23], v[80:83]
    v_exp_f32 v72, v72
    v_mfma_f32_16x16x32_bf16 v[80:83], a[88:91], a[24:27], v[80:83]
    v_exp_f32 v73, v73
    v_mfma_f32_16x16x32_bf16 v[80:83], a[92:95], a[28:31], v[80:83]
    buffer_load_dwordx4 v3, s[8:11], s38 offen offset:2048 nt lds
    v_mfma_f32_16x16x32_bf16 v[88:91], a[96:99], a[16:19], v[48:51]
    s_waitcnt vmcnt(11)
    v_exp_f32 v74, v74
    v_mfma_f32_16x16x32_bf16 v[88:91], a[100:103], a[20:23], v[88:91]
    v_exp_f32 v75, v75
    v_mfma_f32_16x16x32_bf16 v[88:91], a[104:107], a[24:27], v[88:91]
    v_exp_f32 v76, v76
    v_mfma_f32_16x16x32_bf16 v[88:91], a[108:111], a[28:31], v[88:91]
    v_exp_f32 v77, v77
    v_cvt_pk_bf16_f32 v121, v122, v123
    v_cvt_pk_bf16_f32 v122, v124, v125
    v_cvt_pk_bf16_f32 v123, v126, v127
    v_mfma_f32_16x16x32_bf16 v[92:95], a[112:115], a[16:19], v[48:51]
    ds_read_b64 a[16:17], v13 offset:4096
    v_cvt_pk_bf16_f32 v71, v70, v71
    v_mfma_f32_16x16x32_bf16 v[92:95], a[116:119], a[20:23], v[92:95]
    ds_read_b64 a[18:19], v13 offset:4096
    v_cvt_pk_bf16_f32 v70, v68, v69
    v_mfma_f32_16x16x32_bf16 v[92:95], a[120:123], a[24:27], v[92:95]
    ds_read_b64 a[20:21], v13 offset:4352
    v_cvt_pk_bf16_f32 v69, v66, v67
    v_mfma_f32_16x16x32_bf16 v[92:95], a[124:127], a[28:31], v[92:95]
    buffer_load_dwordx4 v3, s[8:11], s38 offen offset:3072 nt lds
    v_mfma_f32_16x16x32_bf16 v[28:31], a[244:247], a[0:3], 0
    s_add_u32 m0, s25, s33
    v_exp_f32 v78, v78
    v_mfma_f32_16x16x32_bf16 v[32:35], a[244:247], a[216:219], 0
    ds_read_b64 a[22:23], v13 offset:4352
    v_cvt_pk_bf16_f32 v68, v64, v65
    v_mfma_f32_16x16x32_bf16 v[224:227], a[128:131], v[116:119], v[224:227]
    ds_read_b64_tr_b16 a[128:129], v11 offset:0
    v_cvt_pk_bf16_f32 v72, v72, v73
    v_mfma_f32_16x16x32_bf16 v[224:227], a[160:163], v[120:123], v[224:227]
    ds_read_b64_tr_b16 a[130:131], v11 offset:4096
    v_cvt_pk_bf16_f32 v28, v28, v29
    v_smfmac_f32_16x16x64_bf16 a[240:243], a[224:227], v[116:123], v4
    ds_read_b64_tr_b16 a[160:161], v11 offset:8192
    v_mfma_f32_16x16x32_bf16 v[36:39], a[244:247], a[4:7], 0
    ds_read_b64_tr_b16 a[162:163], v11 offset:12288
    v_cvt_pk_bf16_f32 v29, v30, v31
    v_mfma_f32_16x16x32_bf16 v[228:231], a[132:135], v[116:119], v[228:231]
    ds_read_b64_tr_b16 a[132:133], v12 offset:0
    v_accvgpr_write_b32 a0, v28
    v_mfma_f32_16x16x32_bf16 v[228:231], a[164:167], v[120:123], v[228:231]
    ds_read_b64_tr_b16 a[134:135], v12 offset:4096
    v_accvgpr_write_b32 a1, v29
    v_mfma_f32_16x16x32_bf16 v[40:43], a[244:247], a[220:223], 0
    ds_read_b64_tr_b16 a[164:165], v12 offset:8192
    v_cvt_pk_bf16_f32 v32, v32, v33
    v_mfma_f32_16x16x32_bf16 v[232:235], a[136:139], v[116:119], v[232:235]
    ds_read_b64_tr_b16 a[166:167], v12 offset:12288
    v_cvt_pk_bf16_f32 v33, v34, v35
    v_mfma_f32_16x16x32_bf16 v[232:235], a[168:171], v[120:123], v[232:235]
    ds_read_b64 a[24:25], v13 offset:4608
    v_accvgpr_write_b32 a2, v32
    v_mfma_f32_16x16x32_bf16 v[28:31], a[244:247], a[8:11], 0
    ds_read_b64 a[26:27], v13 offset:4608
    v_accvgpr_write_b32 a3, v33
    v_mfma_f32_16x16x32_bf16 v[236:239], a[140:143], v[116:119], v[236:239]
    ds_read_b64 a[28:29], v13 offset:4864
    v_cvt_pk_bf16_f32 v36, v36, v37
    v_mfma_f32_16x16x32_bf16 v[236:239], a[172:175], v[120:123], v[236:239]
    buffer_load_dwordx4 v2, s[12:15], s38 offen offset:0 nt lds
    v_mfma_f32_16x16x32_bf16 v[32:35], a[244:247], a[248:251], 0
    ds_read_b64 a[30:31], v13 offset:4864
    v_cvt_pk_bf16_f32 v37, v38, v39
    v_mfma_f32_16x16x32_bf16 v[240:243], a[144:147], v[116:119], v[240:243]
    ds_read_b64_tr_b16 a[136:137], v11 offset:256
    v_accvgpr_write_b32 a4, v36
    v_mfma_f32_16x16x32_bf16 v[240:243], a[176:179], v[120:123], v[240:243]
    ds_read_b64_tr_b16 a[138:139], v11 offset:4352
    v_accvgpr_write_b32 a5, v37
    v_mfma_f32_16x16x32_bf16 v[36:39], a[244:247], a[12:15], 0
    s_waitcnt lgkmcnt(6)
    v_exp_f32 v79, v79
    v_mfma_f32_16x16x32_bf16 v[244:247], a[148:151], v[116:119], v[244:247]
    ds_read_b64_tr_b16 a[168:169], v11 offset:8448
    v_cvt_pk_bf16_f32 v40, v40, v41
    v_mfma_f32_16x16x32_bf16 v[244:247], a[180:183], v[120:123], v[244:247]
    ds_read_b64_tr_b16 a[170:171], v11 offset:12544
    v_cvt_pk_bf16_f32 v41, v42, v43
    v_accvgpr_write_b32 a6, v40
    v_accvgpr_write_b32 a7, v41
    v_mfma_f32_16x16x32_bf16 v[40:43], a[244:247], a[252:255], 0
    ds_read_b64 a[216:217], v13 offset:4104
    v_cvt_pk_bf16_f32 v73, v74, v75
    v_mfma_f32_16x16x32_bf16 v[248:251], a[152:155], v[116:119], v[248:251]
    ds_read_b64 a[218:219], v13 offset:4104
    v_cvt_pk_bf16_f32 v74, v76, v77
    v_mfma_f32_16x16x32_bf16 v[248:251], a[184:187], v[120:123], v[248:251]
    ds_read_b64 a[220:221], v13 offset:4360
    v_cvt_pk_bf16_f32 v75, v78, v79
    v_mfma_f32_16x16x32_bf16 v[252:255], a[156:159], v[116:119], v[252:255]
    ds_read_b64 a[222:223], v13 offset:4360
    v_cvt_pk_bf16_f32 v28, v28, v29
    v_mfma_f32_16x16x32_bf16 v[252:255], a[188:191], v[120:123], v[252:255]
    buffer_load_dwordx4 v3, s[12:15], s38 offen offset:1024 nt lds
    v_mfma_f32_16x16x32_bf16 v[100:103], a[64:67], a[32:35], v[52:55]
    ds_read_b64 a[248:249], v13 offset:4616
    v_cvt_pk_bf16_f32 v29, v30, v31
    v_mfma_f32_16x16x32_bf16 v[100:103], a[68:71], a[36:39], v[100:103]
    ds_read_b64 a[250:251], v13 offset:4616
    v_accvgpr_write_b32 a8, v28
    v_mfma_f32_16x16x32_bf16 v[100:103], a[72:75], a[40:43], v[100:103]
    ds_read_b64 a[252:253], v13 offset:4872
    v_accvgpr_write_b32 a9, v29
    v_mfma_f32_16x16x32_bf16 v[100:103], a[76:79], a[44:47], v[100:103]
    ds_read_b64 a[254:255], v13 offset:4872
    v_cvt_pk_bf16_f32 v32, v32, v33
    v_mfma_f32_16x16x32_bf16 v[96:99], a[80:83], a[32:35], v[52:55]
    ds_read_b64_tr_b16 a[140:141], v12 offset:256
    v_cvt_pk_bf16_f32 v33, v34, v35
    v_mfma_f32_16x16x32_bf16 v[96:99], a[84:87], a[36:39], v[96:99]
    ds_read_b64_tr_b16 a[142:143], v12 offset:4352
    v_accvgpr_write_b32 a10, v32
    v_mfma_f32_16x16x32_bf16 v[96:99], a[88:91], a[40:43], v[96:99]
    ds_read_b64_tr_b16 a[172:173], v12 offset:8448
    v_accvgpr_write_b32 a11, v33
    v_mfma_f32_16x16x32_bf16 v[96:99], a[92:95], a[44:47], v[96:99]
    buffer_load_dwordx4 v2, s[12:15], s38 offen offset:2048 nt lds
    v_mfma_f32_16x16x32_bf16 v[104:107], a[96:99], a[32:35], v[52:55]
    ds_read_b64_tr_b16 a[174:175], v12 offset:12544
    v_cvt_pk_bf16_f32 v36, v36, v37
    v_mfma_f32_16x16x32_bf16 v[104:107], a[100:103], a[36:39], v[104:107]
    ds_read_b64_tr_b16 a[144:145], v11 offset:512
    v_cvt_pk_bf16_f32 v37, v38, v39
    v_mfma_f32_16x16x32_bf16 v[104:107], a[104:107], a[40:43], v[104:107]
    ds_read_b64_tr_b16 a[146:147], v11 offset:4608
    v_accvgpr_write_b32 a12, v36
    v_mfma_f32_16x16x32_bf16 v[104:107], a[108:111], a[44:47], v[104:107]
    s_waitcnt lgkmcnt(6)
    v_exp_f32 v87, v87
    v_mfma_f32_16x16x32_bf16 v[108:111], a[112:115], a[32:35], v[52:55]
    ds_read_b64_tr_b16 a[176:177], v11 offset:8704
    v_accvgpr_write_b32 a13, v37
    v_mfma_f32_16x16x32_bf16 v[108:111], a[116:119], a[36:39], v[108:111]
    ds_read_b64_tr_b16 a[178:179], v11 offset:12800
    v_cvt_pk_bf16_f32 v40, v40, v41
    v_mfma_f32_16x16x32_bf16 v[108:111], a[120:123], a[40:43], v[108:111]
    ds_read_b64_tr_b16 a[148:149], v12 offset:512
    v_cvt_pk_bf16_f32 v41, v42, v43
    v_mfma_f32_16x16x32_bf16 v[108:111], a[124:127], a[44:47], v[108:111]
    ds_read_b64_tr_b16 a[150:151], v12 offset:4608
    v_accvgpr_write_b32 a14, v40
    v_smfmac_f32_16x16x64_bf16 a[228:231], a[224:227], v[68:75], v4
    ds_read_b64_tr_b16 a[180:181], v12 offset:8704
    v_mfma_f32_16x16x32_bf16 v[28:31], a[244:247], a[16:19], 0
    ds_read_b64_tr_b16 a[182:183], v12 offset:12800
    v_accvgpr_write_b32 a15, v41
    v_mfma_f32_16x16x32_bf16 v[32:35], a[244:247], a[216:219], 0
    s_waitcnt lgkmcnt(8)
    ds_read_b64_tr_b16 a[152:153], v11 offset:768
    v_mfma_f32_16x16x32_bf16 v[128:131], a[128:131], v[68:71], v[128:131]
    ds_read_b64_tr_b16 a[154:155], v11 offset:4864
    v_mfma_f32_16x16x32_bf16 v[128:131], a[160:163], v[72:75], v[128:131]
    buffer_load_dwordx4 v3, s[12:15], s38 offen offset:3072 nt lds
    v_mfma_f32_16x16x32_bf16 v[36:39], a[244:247], a[20:23], 0
    ds_read_b64_tr_b16 a[184:185], v11 offset:8960
    v_cvt_pk_bf16_f32 v28, v28, v29
    v_mfma_f32_16x16x32_bf16 v[132:135], a[132:135], v[68:71], v[132:135]
    ds_read_b64_tr_b16 a[186:187], v11 offset:13056
    v_cvt_pk_bf16_f32 v29, v30, v31
    v_mfma_f32_16x16x32_bf16 v[132:135], a[164:167], v[72:75], v[132:135]
    ds_read_b64_tr_b16 a[156:157], v12 offset:768
    v_accvgpr_write_b32 a16, v28
    v_mfma_f32_16x16x32_bf16 v[40:43], a[244:247], a[220:223], 0
    ds_read_b64_tr_b16 a[158:159], v12 offset:4864
    v_accvgpr_write_b32 a17, v29
    v_mfma_f32_16x16x32_bf16 v[136:139], a[136:139], v[68:71], v[136:139]
    ds_read_b64_tr_b16 a[188:189], v12 offset:8960
    v_cvt_pk_bf16_f32 v32, v32, v33
    v_mfma_f32_16x16x32_bf16 v[136:139], a[168:171], v[72:75], v[136:139]
    ds_read_b64_tr_b16 a[190:191], v12 offset:13056
    v_cvt_pk_bf16_f32 v33, v34, v35
    v_mfma_f32_16x16x32_bf16 v[28:31], a[244:247], a[24:27], 0
    s_waitcnt lgkmcnt(8)
    v_exp_f32 v86, v86
    v_mfma_f32_16x16x32_bf16 v[140:143], a[140:143], v[68:71], v[140:143]
    s_add_u32 s38, s36, 32768
    v_exp_f32 v85, v85
    v_mfma_f32_16x16x32_bf16 v[140:143], a[172:175], v[72:75], v[140:143]
    s_add_u32 m0, s26, s32
    v_exp_f32 v84, v84
    v_accvgpr_write_b32 a18, v32
    v_accvgpr_write_b32 a19, v33
    v_mfma_f32_16x16x32_bf16 v[32:35], a[244:247], a[248:251], 0
    s_waitcnt vmcnt(12)
    v_exp_f32 v83, v83
    v_mfma_f32_16x16x32_bf16 v[144:147], a[144:147], v[68:71], v[144:147]
    ds_read_b64 a[32:33], v13 offset:8192
    v_cvt_pk_bf16_f32 v36, v36, v37
    v_mfma_f32_16x16x32_bf16 v[144:147], a[176:179], v[72:75], v[144:147]
    ds_read_b64 a[34:35], v13 offset:8192
    v_cvt_pk_bf16_f32 v37, v38, v39
    v_accvgpr_write_b32 a20, v36
    v_accvgpr_write_b32 a21, v37
    v_mfma_f32_16x16x32_bf16 v[36:39], a[244:247], a[28:31], 0
    ds_read_b64 a[36:37], v13 offset:8448
    v_cvt_pk_bf16_f32 v40, v40, v41
    v_mfma_f32_16x16x32_bf16 v[148:151], a[148:151], v[68:71], v[148:151]
    s_waitcnt lgkmcnt(3)
    v_exp_f32 v82, v82
    v_mfma_f32_16x16x32_bf16 v[148:151], a[180:183], v[72:75], v[148:151]
    ds_read_b64 a[38:39], v13 offset:8448
    v_cvt_pk_bf16_f32 v41, v42, v43
    v_accvgpr_write_b32 a22, v40
    v_accvgpr_write_b32 a23, v41
    v_mfma_f32_16x16x32_bf16 v[40:43], a[244:247], a[252:255], 0
    ds_read_b64 a[40:41], v13 offset:8704
    v_cvt_pk_bf16_f32 v87, v86, v87
    v_mfma_f32_16x16x32_bf16 v[152:155], a[152:155], v[68:71], v[152:155]
    ds_read_b64 a[42:43], v13 offset:8704
    v_cvt_pk_bf16_f32 v86, v84, v85
    v_mfma_f32_16x16x32_bf16 v[152:155], a[184:187], v[72:75], v[152:155]
    ds_read_b64 a[44:45], v13 offset:8960
    v_cvt_pk_bf16_f32 v85, v82, v83
    v_mfma_f32_16x16x32_bf16 v[156:159], a[156:159], v[68:71], v[156:159]
    ds_read_b64 a[46:47], v13 offset:8960
    v_cvt_pk_bf16_f32 v28, v28, v29
    v_mfma_f32_16x16x32_bf16 v[156:159], a[188:191], v[72:75], v[156:159]
    s_barrier
    v_mfma_f32_16x16x32_bf16 v[116:119], a[64:67], a[48:51], v[56:59]
    ds_read_b64 a[216:217], v13 offset:8200
    v_add_u32 v10, s27, v7
    v_mfma_f32_16x16x32_bf16 v[116:119], a[68:71], a[52:55], v[116:119]
    ds_read_b64 a[218:219], v13 offset:8200
    v_cvt_pk_bf16_f32 v29, v30, v31
    v_mfma_f32_16x16x32_bf16 v[116:119], a[72:75], a[56:59], v[116:119]
    ds_read_b64 a[220:221], v13 offset:8456
    v_accvgpr_write_b32 a24, v28
    v_mfma_f32_16x16x32_bf16 v[116:119], a[76:79], a[60:63], v[116:119]
    ds_read_b64 a[222:223], v13 offset:8456
    v_accvgpr_write_b32 a25, v29
    v_mfma_f32_16x16x32_bf16 v[112:115], a[80:83], a[48:51], v[56:59]
    ds_read_b64 a[248:249], v13 offset:8712
    v_cvt_pk_bf16_f32 v32, v32, v33
    v_mfma_f32_16x16x32_bf16 v[112:115], a[84:87], a[52:55], v[112:115]
    ds_read_b64 a[250:251], v13 offset:8712
    v_cvt_pk_bf16_f32 v33, v34, v35
    v_mfma_f32_16x16x32_bf16 v[112:115], a[88:91], a[56:59], v[112:115]
    ds_read_b64 a[252:253], v13 offset:8968
    v_accvgpr_write_b32 a26, v32
    v_mfma_f32_16x16x32_bf16 v[112:115], a[92:95], a[60:63], v[112:115]
    ds_read_b64 a[254:255], v13 offset:8968
    v_accvgpr_write_b32 a27, v33
    v_mfma_f32_16x16x32_bf16 v[120:123], a[96:99], a[48:51], v[56:59]
    ds_read_b128 a[64:67], v10 offset:4096
    v_cvt_pk_bf16_f32 v36, v36, v37
    v_mfma_f32_16x16x32_bf16 v[120:123], a[100:103], a[52:55], v[120:123]
    ds_read_b128 a[68:71], v10 offset:4352
    v_cvt_pk_bf16_f32 v37, v38, v39
    v_mfma_f32_16x16x32_bf16 v[120:123], a[104:107], a[56:59], v[120:123]
    ds_read_b128 a[72:75], v10 offset:4608
    v_accvgpr_write_b32 a28, v36
    v_mfma_f32_16x16x32_bf16 v[120:123], a[108:111], a[60:63], v[120:123]
    buffer_load_dwordx4 v2, s[8:11], s38 offen offset:0 nt lds
    v_exp_f32 v81, v81
    v_exp_f32 v80, v80
    v_exp_f32 v88, v88
    v_cvt_pk_bf16_f32 v84, v80, v81
    v_exp_f32 v89, v89
    v_exp_f32 v90, v90
    v_cvt_pk_bf16_f32 v88, v88, v89
    v_exp_f32 v91, v91
    v_exp_f32 v92, v92
    v_cvt_pk_bf16_f32 v89, v90, v91
    v_exp_f32 v93, v93
    v_exp_f32 v94, v94
    v_cvt_pk_bf16_f32 v90, v92, v93
    v_exp_f32 v95, v95
    s_nop 0
    v_cvt_pk_bf16_f32 v91, v94, v95
    v_mfma_f32_16x16x32_bf16 v[124:127], a[112:115], a[48:51], v[56:59]
    ds_read_b128 a[76:79], v10 offset:4864
    v_accvgpr_write_b32 a29, v37
    v_mfma_f32_16x16x32_bf16 v[124:127], a[116:119], a[52:55], v[124:127]
    ds_read_b128 a[80:83], v10 offset:0
    v_cvt_pk_bf16_f32 v40, v40, v41
    v_mfma_f32_16x16x32_bf16 v[124:127], a[120:123], a[56:59], v[124:127]
    ds_read_b128 a[84:87], v10 offset:256
    v_cvt_pk_bf16_f32 v41, v42, v43
    v_mfma_f32_16x16x32_bf16 v[124:127], a[124:127], a[60:63], v[124:127]
    s_waitcnt lgkmcnt(6)
    v_exp_f32 v103, v103
    v_smfmac_f32_16x16x64_bf16 a[232:235], a[224:227], v[84:91], v4
    ds_read_b128 a[88:91], v10 offset:512
    v_mfma_f32_16x16x32_bf16 v[28:31], a[244:247], a[32:35], 0
    ds_read_b128 a[92:95], v10 offset:768
    v_accvgpr_write_b32 a30, v40
    v_mfma_f32_16x16x32_bf16 v[32:35], a[244:247], a[216:219], 0
    s_waitcnt vmcnt(9)
    v_exp_f32 v102, v102
    v_mfma_f32_16x16x32_bf16 v[160:163], a[128:131], v[84:87], v[160:163]
    ds_read_b128 a[96:99], v10 offset:8192
    v_accvgpr_write_b32 a31, v41
    v_mfma_f32_16x16x32_bf16 v[160:163], a[160:163], v[88:91], v[160:163]
    ds_read_b64 a[48:49], v13 offset:12288
    v_cvt_pk_bf16_f32 v28, v28, v29
    v_mfma_f32_16x16x32_bf16 v[36:39], a[244:247], a[36:39], 0
    ds_read_b64 a[50:51], v13 offset:12288
    v_cvt_pk_bf16_f32 v29, v30, v31
    v_mfma_f32_16x16x32_bf16 v[164:167], a[132:135], v[84:87], v[164:167]
    ds_read_b128 a[100:103], v10 offset:8448
    v_accvgpr_write_b32 a32, v28
    v_mfma_f32_16x16x32_bf16 v[164:167], a[164:167], v[88:91], v[164:167]
    buffer_load_dwordx4 v2, s[8:11], s38 offen offset:1024 nt lds
    v_mfma_f32_16x16x32_bf16 v[40:43], a[244:247], a[220:223], 0
    ds_read_b64 a[52:53], v13 offset:12544
    v_accvgpr_write_b32 a33, v29
    v_mfma_f32_16x16x32_bf16 v[168:171], a[136:139], v[84:87], v[168:171]
    s_waitcnt lgkmcnt(5)
    v_exp_f32 v101, v101
    v_mfma_f32_16x16x32_bf16 v[168:171], a[168:171], v[88:91], v[168:171]
    ds_read_b128 a[104:107], v10 offset:8704
    v_cvt_pk_bf16_f32 v32, v32, v33
    v_mfma_f32_16x16x32_bf16 v[28:31], a[244:247], a[40:43], 0
    ds_read_b64 a[54:55], v13 offset:12544
    v_cvt_pk_bf16_f32 v33, v34, v35
    v_mfma_f32_16x16x32_bf16 v[172:175], a[140:143], v[84:87], v[172:175]
    ds_read_b128 a[108:111], v10 offset:8960
    v_accvgpr_write_b32 a34, v32
    v_mfma_f32_16x16x32_bf16 v[172:175], a[172:175], v[88:91], v[172:175]
    ds_read_b64 a[56:57], v13 offset:12800
    v_accvgpr_write_b32 a35, v33
    v_mfma_f32_16x16x32_bf16 v[32:35], a[244:247], a[248:251], 0
    ds_read_b64 a[58:59], v13 offset:12800
    v_cvt_pk_bf16_f32 v36, v36, v37
    v_mfma_f32_16x16x32_bf16 v[176:179], a[144:147], v[84:87], v[176:179]
    ds_read_b128 a[112:115], v10 offset:12288
    v_cvt_pk_bf16_f32 v37, v38, v39
    v_mfma_f32_16x16x32_bf16 v[176:179], a[176:179], v[88:91], v[176:179]
    ds_read_b64 a[60:61], v13 offset:13056
    v_accvgpr_write_b32 a36, v36
    v_accvgpr_write_b32 a37, v37
    v_mfma_f32_16x16x32_bf16 v[36:39], a[244:247], a[44:47], 0
    ds_read_b64 a[62:63], v13 offset:13056
    v_cvt_pk_bf16_f32 v40, v40, v41
    v_mfma_f32_16x16x32_bf16 v[180:183], a[148:151], v[84:87], v[180:183]
    ds_read_b128 a[116:119], v10 offset:12544
    v_cvt_pk_bf16_f32 v41, v42, v43
    v_mfma_f32_16x16x32_bf16 v[180:183], a[180:183], v[88:91], v[180:183]
    v_exp_f32 v100, v100
    v_accvgpr_write_b32 a38, v40
    v_accvgpr_write_b32 a39, v41
    v_mfma_f32_16x16x32_bf16 v[40:43], a[244:247], a[252:255], 0
    ds_read_b64 a[216:217], v13 offset:12296
    v_add_u32 v11, s27, v8
    v_mfma_f32_16x16x32_bf16 v[184:187], a[152:155], v[84:87], v[184:187]
    ds_read_b128 a[120:123], v10 offset:12800
    v_add_u32 v12, s27, v9
    v_mfma_f32_16x16x32_bf16 v[184:187], a[184:187], v[88:91], v[184:187]
    buffer_load_dwordx4 v3, s[8:11], s38 offen offset:2048 nt lds
    v_mfma_f32_16x16x32_bf16 v[188:191], a[156:159], v[84:87], v[188:191]
    ds_read_b128 a[124:127], v10 offset:13056
    v_cvt_pk_bf16_f32 v103, v102, v103
    v_mfma_f32_16x16x32_bf16 v[188:191], a[188:191], v[88:91], v[188:191]
    ds_read_b64 a[218:219], v13 offset:12296
    v_cvt_pk_bf16_f32 v102, v100, v101
    v_mfma_f32_16x16x32_bf16 v[68:71], a[64:67], a[0:3], 0
    ds_read_b64 a[220:221], v13 offset:12552
    v_cvt_pk_bf16_f32 v28, v28, v29
    v_mfma_f32_16x16x32_bf16 v[68:71], a[68:71], a[4:7], v[68:71]
    ds_read_b64 a[222:223], v13 offset:12552
    v_cvt_pk_bf16_f32 v29, v30, v31
    v_mfma_f32_16x16x32_bf16 v[68:71], a[72:75], a[8:11], v[68:71]
    ds_read_b64 a[248:249], v13 offset:12808
    v_accvgpr_write_b32 a40, v28
    v_mfma_f32_16x16x32_bf16 v[68:71], a[76:79], a[12:15], v[68:71]
    ds_read_b64 a[250:251], v13 offset:12808
    v_accvgpr_write_b32 a41, v29
    v_mfma_f32_16x16x32_bf16 v[64:67], a[80:83], a[0:3], 0
    ds_read_b64 a[252:253], v13 offset:13064
    v_cvt_pk_bf16_f32 v32, v32, v33
    v_mfma_f32_16x16x32_bf16 v[64:67], a[84:87], a[4:7], v[64:67]
    ds_read_b64 a[254:255], v13 offset:13064
    v_cvt_pk_bf16_f32 v33, v34, v35
    v_mfma_f32_16x16x32_bf16 v[64:67], a[88:91], a[8:11], v[64:67]
    s_waitcnt lgkmcnt(7)
    v_exp_f32 v99, v99
    v_mfma_f32_16x16x32_bf16 v[64:67], a[92:95], a[12:15], v[64:67]
    buffer_load_dwordx4 v3, s[8:11], s38 offen offset:3072 nt lds
    v_mfma_f32_16x16x32_bf16 v[72:75], a[96:99], a[0:3], 0
    s_add_u32 m0, s26, s33
    v_exp_f32 v98, v98
    v_mfma_f32_16x16x32_bf16 v[72:75], a[100:103], a[4:7], v[72:75]
    v_exp_f32 v97, v97
    v_mfma_f32_16x16x32_bf16 v[72:75], a[104:107], a[8:11], v[72:75]
    v_exp_f32 v96, v96
    v_mfma_f32_16x16x32_bf16 v[72:75], a[108:111], a[12:15], v[72:75]
    v_exp_f32 v104, v104
    v_cvt_pk_bf16_f32 v101, v98, v99
    v_cvt_pk_bf16_f32 v100, v96, v97
    v_exp_f32 v105, v105
    v_exp_f32 v106, v106
    v_cvt_pk_bf16_f32 v104, v104, v105
    v_exp_f32 v107, v107
    v_exp_f32 v108, v108
    v_cvt_pk_bf16_f32 v105, v106, v107
    v_exp_f32 v109, v109
    v_exp_f32 v110, v110
    v_cvt_pk_bf16_f32 v106, v108, v109
    v_exp_f32 v111, v111
    s_nop 0
    v_cvt_pk_bf16_f32 v107, v110, v111
    v_mfma_f32_16x16x32_bf16 v[76:79], a[112:115], a[0:3], 0
    v_exp_f32 v119, v119
    v_mfma_f32_16x16x32_bf16 v[76:79], a[116:119], a[4:7], v[76:79]
    s_waitcnt lgkmcnt(0)
    v_exp_f32 v118, v118
    v_mfma_f32_16x16x32_bf16 v[76:79], a[120:123], a[8:11], v[76:79]
    v_exp_f32 v117, v117
    v_mfma_f32_16x16x32_bf16 v[76:79], a[124:127], a[12:15], v[76:79]
    v_exp_f32 v116, v116
    v_smfmac_f32_16x16x64_bf16 a[236:239], a[224:227], v[100:107], v4
    v_accvgpr_write_b32 a42, v32
    v_mfma_f32_16x16x32_bf16 v[28:31], a[244:247], a[48:51], 0
    v_exp_f32 v115, v115
    v_accvgpr_write_b32 a43, v33
    v_mfma_f32_16x16x32_bf16 v[32:35], a[244:247], a[216:219], 0
    v_exp_f32 v114, v114
    v_mfma_f32_16x16x32_bf16 v[192:195], a[128:131], v[100:103], v[192:195]
    v_exp_f32 v113, v113
    v_mfma_f32_16x16x32_bf16 v[192:195], a[160:163], v[104:107], v[192:195]
    v_exp_f32 v112, v112
    v_cvt_pk_bf16_f32 v36, v36, v37
    v_cvt_pk_bf16_f32 v37, v38, v39
    v_accvgpr_write_b32 a44, v36
    v_accvgpr_write_b32 a45, v37
    v_mfma_f32_16x16x32_bf16 v[36:39], a[244:247], a[52:55], 0
    v_exp_f32 v120, v120
    v_mfma_f32_16x16x32_bf16 v[196:199], a[132:135], v[100:103], v[196:199]
    v_exp_f32 v121, v121
    v_mfma_f32_16x16x32_bf16 v[196:199], a[164:167], v[104:107], v[196:199]
    buffer_load_dwordx4 v2, s[12:15], s38 offen offset:0 nt lds
    v_cvt_pk_bf16_f32 v40, v40, v41
    v_cvt_pk_bf16_f32 v41, v42, v43
    v_accvgpr_write_b32 a46, v40
    v_accvgpr_write_b32 a47, v41
    v_mfma_f32_16x16x32_bf16 v[40:43], a[244:247], a[220:223], 0
    v_exp_f32 v122, v122
    v_mfma_f32_16x16x32_bf16 v[200:203], a[136:139], v[100:103], v[200:203]
    v_exp_f32 v123, v123
    v_mfma_f32_16x16x32_bf16 v[200:203], a[168:171], v[104:107], v[200:203]
    v_exp_f32 v124, v124
    v_cvt_pk_bf16_f32 v28, v28, v29
    v_cvt_pk_bf16_f32 v29, v30, v31
    v_accvgpr_write_b32 a48, v28
    v_accvgpr_write_b32 a49, v29
    v_mfma_f32_16x16x32_bf16 v[28:31], a[244:247], a[56:59], 0
    v_exp_f32 v125, v125
    v_mfma_f32_16x16x32_bf16 v[204:207], a[140:143], v[100:103], v[204:207]
    v_exp_f32 v126, v126
    v_mfma_f32_16x16x32_bf16 v[204:207], a[172:175], v[104:107], v[204:207]
    v_exp_f32 v127, v127
    v_cvt_pk_bf16_f32 v32, v32, v33
    v_cvt_pk_bf16_f32 v33, v34, v35
    v_accvgpr_write_b32 a50, v32
    v_accvgpr_write_b32 a51, v33
    v_mfma_f32_16x16x32_bf16 v[32:35], a[244:247], a[248:251], 0
    v_cvt_pk_bf16_f32 v36, v36, v37
    v_cvt_pk_bf16_f32 v37, v38, v39
    v_mfma_f32_16x16x32_bf16 v[208:211], a[144:147], v[100:103], v[208:211]
    v_accvgpr_write_b32 a52, v36
    v_accvgpr_write_b32 a53, v37
    v_mfma_f32_16x16x32_bf16 v[208:211], a[176:179], v[104:107], v[208:211]
    v_cvt_pk_bf16_f32 v40, v40, v41
    v_cvt_pk_bf16_f32 v41, v42, v43
    v_mfma_f32_16x16x32_bf16 v[36:39], a[244:247], a[60:63], 0
    v_accvgpr_write_b32 a54, v40
    v_accvgpr_write_b32 a55, v41
    v_mfma_f32_16x16x32_bf16 v[212:215], a[148:151], v[100:103], v[212:215]
    v_accvgpr_read_b32 v60, a228
    v_accvgpr_read_b32 v5, a229
    v_mfma_f32_16x16x32_bf16 v[212:215], a[180:183], v[104:107], v[212:215]
    v_add_f32 v60, v60, v5
    v_cvt_pk_bf16_f32 v119, v118, v119
    v_mfma_f32_16x16x32_bf16 v[40:43], a[244:247], a[252:255], 0
    v_rcp_f32 v60, v60
    v_mfma_f32_16x16x32_bf16 v[216:219], a[152:155], v[100:103], v[216:219]
    v_cvt_pk_bf16_f32 v118, v116, v117
    v_cvt_pk_bf16_f32 v117, v114, v115
    v_mfma_f32_16x16x32_bf16 v[216:219], a[184:187], v[104:107], v[216:219]
    buffer_load_dwordx4 v3, s[12:15], s38 offen offset:1024 nt lds
    v_cvt_pk_bf16_f32 v116, v112, v113
    v_cvt_pk_bf16_f32 v120, v120, v121
    v_pk_mul_f32 v[128:129], v[128:129], v[60:61] op_sel_hi:[1,0]
    v_pk_mul_f32 v[130:131], v[130:131], v[60:61] op_sel_hi:[1,0]
    v_pk_mul_f32 v[132:133], v[132:133], v[60:61] op_sel_hi:[1,0]
    v_pk_mul_f32 v[134:135], v[134:135], v[60:61] op_sel_hi:[1,0]
    v_pk_mul_f32 v[136:137], v[136:137], v[60:61] op_sel_hi:[1,0]
    v_pk_mul_f32 v[138:139], v[138:139], v[60:61] op_sel_hi:[1,0]
    v_pk_mul_f32 v[140:141], v[140:141], v[60:61] op_sel_hi:[1,0]
    v_pk_mul_f32 v[142:143], v[142:143], v[60:61] op_sel_hi:[1,0]
    v_pk_mul_f32 v[144:145], v[144:145], v[60:61] op_sel_hi:[1,0]
    v_pk_mul_f32 v[146:147], v[146:147], v[60:61] op_sel_hi:[1,0]
    v_pk_mul_f32 v[148:149], v[148:149], v[60:61] op_sel_hi:[1,0]
    v_pk_mul_f32 v[150:151], v[150:151], v[60:61] op_sel_hi:[1,0]
    v_pk_mul_f32 v[152:153], v[152:153], v[60:61] op_sel_hi:[1,0]
    v_pk_mul_f32 v[154:155], v[154:155], v[60:61] op_sel_hi:[1,0]
    v_pk_mul_f32 v[156:157], v[156:157], v[60:61] op_sel_hi:[1,0]
    v_pk_mul_f32 v[158:159], v[158:159], v[60:61] op_sel_hi:[1,0]
    v_cvt_pk_bf16_f32 v128, v128, v129
    v_cvt_pk_bf16_f32 v132, v132, v133
    v_cvt_pk_bf16_f32 v136, v136, v137
    v_cvt_pk_bf16_f32 v140, v140, v141
    v_cvt_pk_bf16_f32 v144, v144, v145
    v_cvt_pk_bf16_f32 v148, v148, v149
    v_cvt_pk_bf16_f32 v152, v152, v153
    v_cvt_pk_bf16_f32 v156, v156, v157
    v_cvt_pk_bf16_f32 v129, v130, v131
    v_cvt_pk_bf16_f32 v133, v134, v135
    v_cvt_pk_bf16_f32 v137, v138, v139
    v_cvt_pk_bf16_f32 v141, v142, v143
    v_cvt_pk_bf16_f32 v145, v146, v147
    v_cvt_pk_bf16_f32 v149, v150, v151
    v_cvt_pk_bf16_f32 v153, v154, v155
    v_cvt_pk_bf16_f32 v157, v158, v159
    ds_write_b64 v15, v[128:129] offset:0
    ds_write_b64 v16, v[132:133] offset:0
    ds_write_b64 v17, v[136:137] offset:0
    ds_write_b64 v18, v[140:141] offset:0
    ds_write_b64 v15, v[144:145] offset:128
    ds_write_b64 v16, v[148:149] offset:128
    ds_write_b64 v17, v[152:153] offset:128
    ds_write_b64 v18, v[156:157] offset:128
    v_mfma_f32_16x16x32_bf16 v[220:223], a[156:159], v[100:103], v[220:223]
    ds_read_b128 a[192:195], v19 offset:0
    v_cvt_pk_bf16_f32 v121, v122, v123
    v_mfma_f32_16x16x32_bf16 v[220:223], a[188:191], v[104:107], v[220:223]
    ds_read_b128 a[196:199], v20 offset:1024
    v_cvt_pk_bf16_f32 v122, v124, v125
    v_mfma_f32_16x16x32_bf16 v[84:87], a[64:67], a[16:19], 0
    ds_read_b128 a[200:203], v19 offset:2048
    v_cvt_pk_bf16_f32 v123, v126, v127
    v_mfma_f32_16x16x32_bf16 v[84:87], a[68:71], a[20:23], v[84:87]
    ds_read_b128 a[204:207], v20 offset:3072
    v_max3_f32 v26, v64, v65, v66
    v_mfma_f32_16x16x32_bf16 v[84:87], a[72:75], a[24:27], v[84:87]
    v_max3_f32 v27, v67, v68, v69
    v_max3_f32 v26, v26, v70, v71
    v_mfma_f32_16x16x32_bf16 v[84:87], a[76:79], a[28:31], v[84:87]
    v_max_f32 v26, v26, v27
    v_mov_b32 v27, v26
    v_mfma_f32_16x16x32_bf16 v[80:83], a[80:83], a[16:19], 0
    v_accvgpr_write_b32 a228, 0
    v_accvgpr_write_b32 a229, 0
    v_mfma_f32_16x16x32_bf16 v[80:83], a[84:87], a[20:23], v[80:83]
    v_permlane32_swap_b32 v26, v27
    v_mfma_f32_16x16x32_bf16 v[80:83], a[88:91], a[24:27], v[80:83]
    s_waitcnt lgkmcnt(3)
    v_max_f32 v26, v26, v27
    v_mov_b32 v27, v26
    v_mfma_f32_16x16x32_bf16 v[80:83], a[92:95], a[28:31], v[80:83]
    buffer_store_dwordx4 a[192:195], v21, s[20:23], s28 offen offset:0 nt
    v_mfma_f32_16x16x32_bf16 v[88:91], a[96:99], a[16:19], 0
    s_waitcnt lgkmcnt(2)
    v_permlane16_swap_b32 v26, v27
    v_mfma_f32_16x16x32_bf16 v[88:91], a[100:103], a[20:23], v[88:91]
    s_waitcnt lgkmcnt(1)
    v_min_f32_e64 v44, -v26, -v27
    v_cvt_pk_bf16_f32 v28, v28, v29
    v_mfma_f32_16x16x32_bf16 v[88:91], a[104:107], a[24:27], v[88:91]
    s_waitcnt lgkmcnt(0)
    v_cvt_pk_bf16_f32 v32, v32, v33
    v_cvt_pk_bf16_f32 v36, v36, v37
    v_mfma_f32_16x16x32_bf16 v[88:91], a[108:111], a[28:31], v[88:91]
    v_cvt_pk_bf16_f32 v40, v40, v41
    v_cvt_pk_bf16_f32 v29, v30, v31
    v_cvt_pk_bf16_f32 v33, v34, v35
    v_cvt_pk_bf16_f32 v37, v38, v39
    v_cvt_pk_bf16_f32 v41, v42, v43
    v_pk_add_f32 v[64:65], v[64:65], v[44:45] op_sel_hi:[1,0]
    v_pk_add_f32 v[66:67], v[66:67], v[44:45] op_sel_hi:[1,0]
    v_pk_add_f32 v[68:69], v[68:69], v[44:45] op_sel_hi:[1,0]
    v_pk_add_f32 v[70:71], v[70:71], v[44:45] op_sel_hi:[1,0]
    v_pk_add_f32 v[72:73], v[72:73], v[44:45] op_sel_hi:[1,0]
    v_pk_add_f32 v[74:75], v[74:75], v[44:45] op_sel_hi:[1,0]
    v_pk_add_f32 v[76:77], v[76:77], v[44:45] op_sel_hi:[1,0]
    v_pk_add_f32 v[78:79], v[78:79], v[44:45] op_sel_hi:[1,0]
    v_mfma_f32_16x16x32_bf16 v[92:95], a[112:115], a[16:19], 0
    v_exp_f32 v71, v71
    v_mfma_f32_16x16x32_bf16 v[92:95], a[116:119], a[20:23], v[92:95]
    v_exp_f32 v70, v70
    v_mfma_f32_16x16x32_bf16 v[92:95], a[120:123], a[24:27], v[92:95]
    v_exp_f32 v69, v69
    v_mfma_f32_16x16x32_bf16 v[92:95], a[124:127], a[28:31], v[92:95]
    v_exp_f32 v68, v68
    v_smfmac_f32_16x16x64_bf16 a[240:243], a[224:227], v[116:123], v4
    v_cvt_pk_bf16_f32 v71, v70, v71
    v_mfma_f32_16x16x32_bf16 v[224:227], a[128:131], v[116:119], v[224:227]
    ds_read_b64_tr_b16 a[128:129], v11 offset:0
    v_cvt_pk_bf16_f32 v70, v68, v69
    v_mfma_f32_16x16x32_bf16 v[224:227], a[160:163], v[120:123], v[224:227]
    buffer_load_dwordx4 v2, s[12:15], s38 offen offset:2048 nt lds
    v_mfma_f32_16x16x32_bf16 v[228:231], a[132:135], v[116:119], v[228:231]
    ds_read_b64_tr_b16 a[130:131], v11 offset:4096
    v_accvgpr_write_b32 a56, v28
    v_mfma_f32_16x16x32_bf16 v[228:231], a[164:167], v[120:123], v[228:231]
    ds_read_b64_tr_b16 a[160:161], v11 offset:8192
    v_accvgpr_write_b32 a58, v32
    v_mfma_f32_16x16x32_bf16 v[232:235], a[136:139], v[116:119], v[232:235]
    ds_read_b64_tr_b16 a[162:163], v11 offset:12288
    v_accvgpr_write_b32 a60, v36
    v_mfma_f32_16x16x32_bf16 v[232:235], a[168:171], v[120:123], v[232:235]
    ds_read_b64_tr_b16 a[132:133], v12 offset:0
    v_accvgpr_write_b32 a62, v40
    v_mfma_f32_16x16x32_bf16 v[236:239], a[140:143], v[116:119], v[236:239]
    ds_read_b64_tr_b16 a[134:135], v12 offset:4096
    v_accvgpr_write_b32 a57, v29
    v_mfma_f32_16x16x32_bf16 v[236:239], a[172:175], v[120:123], v[236:239]
    ds_read_b64_tr_b16 a[164:165], v12 offset:8192
    v_accvgpr_write_b32 a59, v33
    v_mfma_f32_16x16x32_bf16 v[240:243], a[144:147], v[116:119], v[240:243]
    ds_read_b64_tr_b16 a[166:167], v12 offset:12288
    v_accvgpr_write_b32 a61, v37
    v_mfma_f32_16x16x32_bf16 v[240:243], a[176:179], v[120:123], v[240:243]
    ds_read_b64_tr_b16 a[136:137], v11 offset:256
    v_accvgpr_write_b32 a63, v41
    v_mfma_f32_16x16x32_bf16 v[244:247], a[148:151], v[116:119], v[244:247]
    ds_read_b64_tr_b16 a[138:139], v11 offset:4352
    v_accvgpr_read_b32 v61, a232
    v_mfma_f32_16x16x32_bf16 v[244:247], a[180:183], v[120:123], v[244:247]
    buffer_store_dwordx4 a[196:199], v21, s[20:23], s28 offen offset:1024 nt
    v_mfma_f32_16x16x32_bf16 v[248:251], a[152:155], v[116:119], v[248:251]
    ds_read_b64_tr_b16 a[168:169], v11 offset:8448
    v_accvgpr_read_b32 v6, a233
    v_mfma_f32_16x16x32_bf16 v[248:251], a[184:187], v[120:123], v[248:251]
    ds_read_b64_tr_b16 a[170:171], v11 offset:12544
    v_add_f32 v61, v61, v6
    v_mfma_f32_16x16x32_bf16 v[252:255], a[156:159], v[116:119], v[252:255]
    ds_read_b64_tr_b16 a[140:141], v12 offset:256
    v_max3_f32 v24, v80, v81, v82
    v_mfma_f32_16x16x32_bf16 v[252:255], a[188:191], v[120:123], v[252:255]
    ds_read_b64_tr_b16 a[142:143], v12 offset:4352
    v_max3_f32 v25, v83, v84, v85
    v_mfma_f32_16x16x32_bf16 v[100:103], a[64:67], a[32:35], 0
    ds_read_b64_tr_b16 a[172:173], v12 offset:8448
    v_max3_f32 v24, v24, v86, v87
    v_mfma_f32_16x16x32_bf16 v[100:103], a[68:71], a[36:39], v[100:103]
    ds_read_b64_tr_b16 a[174:175], v12 offset:12544
    v_max_f32 v24, v24, v25
    v_mfma_f32_16x16x32_bf16 v[100:103], a[72:75], a[40:43], v[100:103]
    s_waitcnt lgkmcnt(8)
    ds_read_b64_tr_b16 a[144:145], v11 offset:512
    v_mfma_f32_16x16x32_bf16 v[100:103], a[76:79], a[44:47], v[100:103]
    ds_read_b64_tr_b16 a[146:147], v11 offset:4608
    v_mov_b32 v25, v24
    v_mfma_f32_16x16x32_bf16 v[96:99], a[80:83], a[32:35], 0
    ds_read_b64_tr_b16 a[176:177], v11 offset:8704
    v_accvgpr_write_b32 a232, 0
    v_mfma_f32_16x16x32_bf16 v[96:99], a[84:87], a[36:39], v[96:99]
    ds_read_b64_tr_b16 a[178:179], v11 offset:12800
    v_accvgpr_write_b32 a233, 0
    v_mfma_f32_16x16x32_bf16 v[96:99], a[88:91], a[40:43], v[96:99]
    ds_read_b64_tr_b16 a[148:149], v12 offset:512
    v_mov_b32 v45, v44
    v_mfma_f32_16x16x32_bf16 v[96:99], a[92:95], a[44:47], v[96:99]
    buffer_load_dwordx4 v3, s[12:15], s38 offen offset:3072 nt lds
    v_mfma_f32_16x16x32_bf16 v[104:107], a[96:99], a[32:35], 0
    ds_read_b64_tr_b16 a[150:151], v12 offset:4608
    v_mov_b32 v46, v44
    v_mfma_f32_16x16x32_bf16 v[104:107], a[100:103], a[36:39], v[104:107]
    ds_read_b64_tr_b16 a[180:181], v12 offset:8704
    v_mov_b32 v47, v44
    v_mfma_f32_16x16x32_bf16 v[104:107], a[104:107], a[40:43], v[104:107]
    ds_read_b64_tr_b16 a[182:183], v12 offset:12800
    v_accvgpr_read_b32 v62, a236
    v_mfma_f32_16x16x32_bf16 v[104:107], a[108:111], a[44:47], v[104:107]
    s_waitcnt lgkmcnt(8)
    ds_read_b64_tr_b16 a[152:153], v11 offset:768
    v_exp_f32 v67, v67
    v_exp_f32 v66, v66
    v_exp_f32 v65, v65
    v_cvt_pk_bf16_f32 v69, v66, v67
    v_exp_f32 v64, v64
    v_exp_f32 v72, v72
    v_cvt_pk_bf16_f32 v68, v64, v65
    v_exp_f32 v73, v73
    v_exp_f32 v74, v74
    v_cvt_pk_bf16_f32 v72, v72, v73
    v_exp_f32 v75, v75
    v_exp_f32 v76, v76
    v_cvt_pk_bf16_f32 v73, v74, v75
    v_exp_f32 v77, v77
    v_exp_f32 v78, v78
    v_cvt_pk_bf16_f32 v74, v76, v77
    v_exp_f32 v79, v79
    s_nop 0
    v_cvt_pk_bf16_f32 v75, v78, v79
    v_mfma_f32_16x16x32_bf16 v[108:111], a[112:115], a[32:35], 0
    ds_read_b64_tr_b16 a[154:155], v11 offset:4864
    v_accvgpr_read_b32 v14, a237
    v_mfma_f32_16x16x32_bf16 v[108:111], a[116:119], a[36:39], v[108:111]
    ds_read_b64_tr_b16 a[184:185], v11 offset:8960
    v_add_f32 v62, v62, v14
    v_mfma_f32_16x16x32_bf16 v[108:111], a[120:123], a[40:43], v[108:111]
    ds_read_b64_tr_b16 a[186:187], v11 offset:13056
    v_max3_f32 v26, v96, v97, v98
    v_mfma_f32_16x16x32_bf16 v[108:111], a[124:127], a[44:47], v[108:111]
    ds_read_b64_tr_b16 a[156:157], v12 offset:768
    v_max3_f32 v27, v99, v100, v101
    v_mfma_f32_16x16x32_bf16 v[128:131], a[128:131], v[68:71], 0
    ds_read_b64_tr_b16 a[158:159], v12 offset:4864
    v_max3_f32 v26, v26, v102, v103
    v_mfma_f32_16x16x32_bf16 v[128:131], a[160:163], v[72:75], v[128:131]
    buffer_store_dwordx4 a[200:203], v21, s[20:23], s28 offen offset:2048 nt
    v_smfmac_f32_16x16x64_bf16 a[228:231], a[224:227], v[68:75], v4
    ds_read_b64_tr_b16 a[188:189], v12 offset:8960
    v_mfma_f32_16x16x32_bf16 v[132:135], a[132:135], v[68:71], 0
    ds_read_b64_tr_b16 a[190:191], v12 offset:13056
    v_max_f32 v26, v26, v27
    v_mfma_f32_16x16x32_bf16 v[132:135], a[164:167], v[72:75], v[132:135]
    s_waitcnt lgkmcnt(8)
    v_rcp_f32 v61, v61
    v_mfma_f32_16x16x32_bf16 v[136:139], a[136:139], v[68:71], 0
    s_add_u32 s38, s36, 49152
    v_permlane32_swap_b32 v24, v25
    v_mfma_f32_16x16x32_bf16 v[136:139], a[168:171], v[72:75], v[136:139]
    s_add_u32 m0, s27, s32
    v_max_f32 v24, v24, v25
    v_mov_b32 v25, v24
    v_rcp_f32 v62, v62
    v_mov_b32 v27, v26
    v_pk_mul_f32 v[160:161], v[160:161], v[60:61] op_sel:[0,1] op_sel_hi:[1,1]
    v_pk_mul_f32 v[162:163], v[162:163], v[60:61] op_sel:[0,1] op_sel_hi:[1,1]
    v_pk_mul_f32 v[164:165], v[164:165], v[60:61] op_sel:[0,1] op_sel_hi:[1,1]
    v_pk_mul_f32 v[166:167], v[166:167], v[60:61] op_sel:[0,1] op_sel_hi:[1,1]
    v_pk_mul_f32 v[168:169], v[168:169], v[60:61] op_sel:[0,1] op_sel_hi:[1,1]
    v_pk_mul_f32 v[170:171], v[170:171], v[60:61] op_sel:[0,1] op_sel_hi:[1,1]
    v_pk_mul_f32 v[172:173], v[172:173], v[60:61] op_sel:[0,1] op_sel_hi:[1,1]
    v_pk_mul_f32 v[174:175], v[174:175], v[60:61] op_sel:[0,1] op_sel_hi:[1,1]
    v_pk_mul_f32 v[176:177], v[176:177], v[60:61] op_sel:[0,1] op_sel_hi:[1,1]
    v_pk_mul_f32 v[178:179], v[178:179], v[60:61] op_sel:[0,1] op_sel_hi:[1,1]
    v_pk_mul_f32 v[180:181], v[180:181], v[60:61] op_sel:[0,1] op_sel_hi:[1,1]
    v_pk_mul_f32 v[182:183], v[182:183], v[60:61] op_sel:[0,1] op_sel_hi:[1,1]
    v_pk_mul_f32 v[184:185], v[184:185], v[60:61] op_sel:[0,1] op_sel_hi:[1,1]
    v_pk_mul_f32 v[186:187], v[186:187], v[60:61] op_sel:[0,1] op_sel_hi:[1,1]
    v_pk_mul_f32 v[188:189], v[188:189], v[60:61] op_sel:[0,1] op_sel_hi:[1,1]
    v_pk_mul_f32 v[190:191], v[190:191], v[60:61] op_sel:[0,1] op_sel_hi:[1,1]
    v_pk_mul_f32 v[192:193], v[192:193], v[62:63] op_sel_hi:[1,0]
    v_pk_mul_f32 v[194:195], v[194:195], v[62:63] op_sel_hi:[1,0]
    v_pk_mul_f32 v[196:197], v[196:197], v[62:63] op_sel_hi:[1,0]
    v_pk_mul_f32 v[198:199], v[198:199], v[62:63] op_sel_hi:[1,0]
    v_pk_mul_f32 v[200:201], v[200:201], v[62:63] op_sel_hi:[1,0]
    v_pk_mul_f32 v[202:203], v[202:203], v[62:63] op_sel_hi:[1,0]
    v_pk_mul_f32 v[204:205], v[204:205], v[62:63] op_sel_hi:[1,0]
    v_pk_mul_f32 v[206:207], v[206:207], v[62:63] op_sel_hi:[1,0]
    v_pk_mul_f32 v[208:209], v[208:209], v[62:63] op_sel_hi:[1,0]
    v_pk_mul_f32 v[210:211], v[210:211], v[62:63] op_sel_hi:[1,0]
    v_pk_mul_f32 v[212:213], v[212:213], v[62:63] op_sel_hi:[1,0]
    v_pk_mul_f32 v[214:215], v[214:215], v[62:63] op_sel_hi:[1,0]
    v_pk_mul_f32 v[216:217], v[216:217], v[62:63] op_sel_hi:[1,0]
    v_pk_mul_f32 v[218:219], v[218:219], v[62:63] op_sel_hi:[1,0]
    v_pk_mul_f32 v[220:221], v[220:221], v[62:63] op_sel_hi:[1,0]
    v_pk_mul_f32 v[222:223], v[222:223], v[62:63] op_sel_hi:[1,0]
    v_mfma_f32_16x16x32_bf16 v[140:143], a[140:143], v[68:71], 0
    v_permlane16_swap_b32 v24, v25
    v_mfma_f32_16x16x32_bf16 v[140:143], a[172:175], v[72:75], v[140:143]
    v_permlane32_swap_b32 v26, v27
    v_mfma_f32_16x16x32_bf16 v[144:147], a[144:147], v[68:71], 0
    v_min_f32_e64 v48, -v24, -v25
    v_cvt_pk_bf16_f32 v160, v160, v161
    v_mfma_f32_16x16x32_bf16 v[144:147], a[176:179], v[72:75], v[144:147]
    v_cvt_pk_bf16_f32 v164, v164, v165
    v_cvt_pk_bf16_f32 v161, v162, v163
    v_cvt_pk_bf16_f32 v165, v166, v167
    v_cvt_pk_bf16_f32 v168, v168, v169
    v_cvt_pk_bf16_f32 v169, v170, v171
    v_pk_add_f32 v[80:81], v[80:81], v[48:49] op_sel_hi:[1,0]
    v_pk_add_f32 v[82:83], v[82:83], v[48:49] op_sel_hi:[1,0]
    v_pk_add_f32 v[84:85], v[84:85], v[48:49] op_sel_hi:[1,0]
    v_pk_add_f32 v[86:87], v[86:87], v[48:49] op_sel_hi:[1,0]
    v_pk_add_f32 v[88:89], v[88:89], v[48:49] op_sel_hi:[1,0]
    v_pk_add_f32 v[90:91], v[90:91], v[48:49] op_sel_hi:[1,0]
    v_pk_add_f32 v[92:93], v[92:93], v[48:49] op_sel_hi:[1,0]
    v_pk_add_f32 v[94:95], v[94:95], v[48:49] op_sel_hi:[1,0]
    v_mfma_f32_16x16x32_bf16 v[148:151], a[148:151], v[68:71], 0
    s_waitcnt lgkmcnt(0)
    v_exp_f32 v87, v87
    v_mfma_f32_16x16x32_bf16 v[148:151], a[180:183], v[72:75], v[148:151]
    ds_write_b64 v15, v[160:161] offset:4096
    v_mfma_f32_16x16x32_bf16 v[152:155], a[152:155], v[68:71], 0
    v_exp_f32 v86, v86
    v_mfma_f32_16x16x32_bf16 v[152:155], a[184:187], v[72:75], v[152:155]
    ds_write_b64 v16, v[164:165] offset:4096
    v_mfma_f32_16x16x32_bf16 v[156:159], a[156:159], v[68:71], 0
    v_exp_f32 v85, v85
    v_mfma_f32_16x16x32_bf16 v[156:159], a[188:191], v[72:75], v[156:159]
    s_waitcnt vmcnt(11)
    s_barrier
    v_mfma_f32_16x16x32_bf16 v[116:119], a[64:67], a[48:51], 0
    v_exp_f32 v84, v84
    v_add_u32 v10, s25, v7
    v_mfma_f32_16x16x32_bf16 v[116:119], a[68:71], a[52:55], v[116:119]
    ds_read_b128 a[64:67], v10 offset:4096
    v_cvt_pk_bf16_f32 v87, v86, v87
    v_mfma_f32_16x16x32_bf16 v[116:119], a[72:75], a[56:59], v[116:119]
    ds_read_b128 a[68:71], v10 offset:4352
    v_cvt_pk_bf16_f32 v86, v84, v85
    v_mfma_f32_16x16x32_bf16 v[116:119], a[76:79], a[60:63], v[116:119]
    ds_write_b64 v17, v[168:169] offset:4096
    v_mfma_f32_16x16x32_bf16 v[112:115], a[80:83], a[48:51], 0
    ds_read_b128 a[72:75], v10 offset:4608
    v_cvt_pk_bf16_f32 v172, v172, v173
    v_mfma_f32_16x16x32_bf16 v[112:115], a[84:87], a[52:55], v[112:115]
    v_exp_f32 v83, v83
    v_mfma_f32_16x16x32_bf16 v[112:115], a[88:91], a[56:59], v[112:115]
    ds_read_b128 a[76:79], v10 offset:4864
    v_cvt_pk_bf16_f32 v173, v174, v175
    v_mfma_f32_16x16x32_bf16 v[112:115], a[92:95], a[60:63], v[112:115]
    ds_write_b64 v18, v[172:173] offset:4096
    v_mfma_f32_16x16x32_bf16 v[120:123], a[96:99], a[48:51], 0
    ds_read_b128 a[80:83], v10 offset:0
    v_cvt_pk_bf16_f32 v176, v176, v177
    v_mfma_f32_16x16x32_bf16 v[120:123], a[100:103], a[52:55], v[120:123]
    v_exp_f32 v82, v82
    v_mfma_f32_16x16x32_bf16 v[120:123], a[104:107], a[56:59], v[120:123]
    ds_read_b128 a[84:87], v10 offset:256
    v_cvt_pk_bf16_f32 v85, v82, v83
    v_mfma_f32_16x16x32_bf16 v[120:123], a[108:111], a[60:63], v[120:123]
    buffer_load_dwordx4 v2, s[8:11], s38 offen offset:0 nt lds
    v_exp_f32 v81, v81
    v_exp_f32 v80, v80
    v_exp_f32 v88, v88
    v_cvt_pk_bf16_f32 v84, v80, v81
    v_exp_f32 v89, v89
    v_exp_f32 v90, v90
    v_cvt_pk_bf16_f32 v88, v88, v89
    v_exp_f32 v91, v91
    v_exp_f32 v92, v92
    v_cvt_pk_bf16_f32 v89, v90, v91
    v_exp_f32 v93, v93
    v_exp_f32 v94, v94
    v_cvt_pk_bf16_f32 v90, v92, v93
    v_exp_f32 v95, v95
    s_nop 0
    v_cvt_pk_bf16_f32 v91, v94, v95
    v_mfma_f32_16x16x32_bf16 v[124:127], a[112:115], a[48:51], 0
    ds_read_b128 a[88:91], v10 offset:512
    v_cvt_pk_bf16_f32 v177, v178, v179
    v_mfma_f32_16x16x32_bf16 v[124:127], a[116:119], a[52:55], v[124:127]
    v_cvt_pk_bf16_f32 v180, v180, v181
    v_cvt_pk_bf16_f32 v181, v182, v183
    v_mfma_f32_16x16x32_bf16 v[124:127], a[120:123], a[56:59], v[124:127]
    ds_read_b128 a[92:95], v10 offset:768
    v_cvt_pk_bf16_f32 v184, v184, v185
    v_mfma_f32_16x16x32_bf16 v[124:127], a[124:127], a[60:63], v[124:127]
    ds_write_b64 v15, v[176:177] offset:4224
    v_mfma_f32_16x16x32_bf16 v[160:163], a[128:131], v[84:87], 0
    ds_read_b128 a[96:99], v10 offset:8192
    v_cvt_pk_bf16_f32 v185, v186, v187
    v_mfma_f32_16x16x32_bf16 v[160:163], a[160:163], v[88:91], v[160:163]
    buffer_load_dwordx4 v2, s[8:11], s38 offen offset:1024 nt lds
    v_smfmac_f32_16x16x64_bf16 a[232:235], a[224:227], v[84:91], v4
    ds_write_b64 v16, v[180:181] offset:4224
    v_mfma_f32_16x16x32_bf16 v[164:167], a[132:135], v[84:87], 0
    ds_read_b128 a[100:103], v10 offset:8448
    v_cvt_pk_bf16_f32 v188, v188, v189
    v_mfma_f32_16x16x32_bf16 v[164:167], a[164:167], v[88:91], v[164:167]
    ds_write_b64 v17, v[184:185] offset:4224
    v_mfma_f32_16x16x32_bf16 v[168:171], a[136:139], v[84:87], 0
    ds_read_b128 a[104:107], v10 offset:8704
    v_cvt_pk_bf16_f32 v189, v190, v191
    v_mfma_f32_16x16x32_bf16 v[168:171], a[168:171], v[88:91], v[168:171]
    ds_write_b64 v18, v[188:189] offset:4224
    v_mfma_f32_16x16x32_bf16 v[172:175], a[140:143], v[84:87], 0
    s_waitcnt lgkmcnt(7)
    v_add_u32 v11, s25, v8
    v_add_u32 v12, s25, v9
    v_mfma_f32_16x16x32_bf16 v[172:175], a[172:175], v[88:91], v[172:175]
    ds_read_b128 a[108:111], v10 offset:8960
    v_max_f32 v26, v26, v27
    v_mfma_f32_16x16x32_bf16 v[176:179], a[144:147], v[84:87], 0
    ds_read_b128 a[112:115], v10 offset:12288
    v_mov_b32 v27, v26
    v_mfma_f32_16x16x32_bf16 v[176:179], a[176:179], v[88:91], v[176:179]
    buffer_store_dwordx4 a[204:207], v21, s[20:23], s28 offen offset:3072 nt
    v_mfma_f32_16x16x32_bf16 v[180:183], a[148:151], v[84:87], 0
    ds_read_b128 a[116:119], v10 offset:12544
    v_cvt_pk_bf16_f32 v192, v192, v193
    v_mfma_f32_16x16x32_bf16 v[180:183], a[180:183], v[88:91], v[180:183]
    ds_read_b128 a[208:211], v19 offset:4096
    v_cvt_pk_bf16_f32 v196, v196, v197
    v_mfma_f32_16x16x32_bf16 v[184:187], a[152:155], v[84:87], 0
    ds_read_b128 a[120:123], v10 offset:12800
    v_cvt_pk_bf16_f32 v193, v194, v195
    v_mfma_f32_16x16x32_bf16 v[184:187], a[184:187], v[88:91], v[184:187]
    ds_write_b64 v15, v[192:193] offset:8192
    v_mfma_f32_16x16x32_bf16 v[188:191], a[156:159], v[84:87], 0
    ds_read_b128 a[124:127], v10 offset:13056
    v_cvt_pk_bf16_f32 v197, v198, v199
    v_mfma_f32_16x16x32_bf16 v[188:191], a[188:191], v[88:91], v[188:191]
    ds_write_b64 v16, v[196:197] offset:8192
    v_mfma_f32_16x16x32_bf16 v[68:71], a[64:67], a[0:3], v[44:47]
    ds_read_b128 a[212:215], v20 offset:5120
    v_accvgpr_write_b32 a236, 0
    v_mfma_f32_16x16x32_bf16 v[68:71], a[68:71], a[4:7], v[68:71]
    ds_read_b128 a[192:195], v19 offset:6144
    v_accvgpr_write_b32 a237, 0
    v_mfma_f32_16x16x32_bf16 v[68:71], a[72:75], a[8:11], v[68:71]
    ds_read_b128 a[196:199], v20 offset:7168
    v_cvt_pk_bf16_f32 v200, v200, v201
    v_mfma_f32_16x16x32_bf16 v[68:71], a[76:79], a[12:15], v[68:71]
    buffer_load_dwordx4 v3, s[8:11], s38 offen offset:2048 nt lds
    v_mfma_f32_16x16x32_bf16 v[64:67], a[80:83], a[0:3], v[44:47]
    s_waitcnt lgkmcnt(7)
    v_permlane16_swap_b32 v26, v27
    v_mfma_f32_16x16x32_bf16 v[64:67], a[84:87], a[4:7], v[64:67]
    v_min_f32_e64 v52, -v26, -v27
    v_cvt_pk_bf16_f32 v201, v202, v203
    v_mfma_f32_16x16x32_bf16 v[64:67], a[88:91], a[8:11], v[64:67]
    s_waitcnt lgkmcnt(4)
    v_exp_f32 v71, v71
    v_mfma_f32_16x16x32_bf16 v[64:67], a[92:95], a[12:15], v[64:67]
    ds_write_b64 v17, v[200:201] offset:8192
    v_cvt_pk_bf16_f32 v204, v204, v205
    v_cvt_pk_bf16_f32 v205, v206, v207
    v_pk_add_f32 v[96:97], v[96:97], v[52:53] op_sel_hi:[1,0]
    v_pk_add_f32 v[98:99], v[98:99], v[52:53] op_sel_hi:[1,0]
    v_pk_add_f32 v[100:101], v[100:101], v[52:53] op_sel_hi:[1,0]
    v_pk_add_f32 v[102:103], v[102:103], v[52:53] op_sel_hi:[1,0]
    v_pk_add_f32 v[104:105], v[104:105], v[52:53] op_sel_hi:[1,0]
    v_pk_add_f32 v[106:107], v[106:107], v[52:53] op_sel_hi:[1,0]
    v_pk_add_f32 v[108:109], v[108:109], v[52:53] op_sel_hi:[1,0]
    v_pk_add_f32 v[110:111], v[110:111], v[52:53] op_sel_hi:[1,0]
    v_mfma_f32_16x16x32_bf16 v[72:75], a[96:99], a[0:3], v[44:47]
    s_waitcnt lgkmcnt(3)
    v_exp_f32 v103, v103
    v_mfma_f32_16x16x32_bf16 v[72:75], a[100:103], a[4:7], v[72:75]
    s_waitcnt lgkmcnt(2)
    v_exp_f32 v102, v102
    v_mfma_f32_16x16x32_bf16 v[72:75], a[104:107], a[8:11], v[72:75]
    s_waitcnt lgkmcnt(1)
    v_exp_f32 v101, v101
    v_mfma_f32_16x16x32_bf16 v[72:75], a[108:111], a[12:15], v[72:75]
    buffer_store_dwordx4 a[208:211], v21, s[20:23], s29 offen offset:0 nt
    v_cvt_pk_bf16_f32 v103, v102, v103
    v_exp_f32 v100, v100
    v_exp_f32 v99, v99
    v_cvt_pk_bf16_f32 v102, v100, v101
    v_exp_f32 v98, v98
    v_exp_f32 v97, v97
    v_cvt_pk_bf16_f32 v101, v98, v99
    v_exp_f32 v96, v96
    v_exp_f32 v104, v104
    v_cvt_pk_bf16_f32 v100, v96, v97
    v_exp_f32 v105, v105
    v_exp_f32 v106, v106
    v_cvt_pk_bf16_f32 v104, v104, v105
    v_exp_f32 v107, v107
    v_exp_f32 v108, v108
    v_cvt_pk_bf16_f32 v105, v106, v107
    v_exp_f32 v109, v109
    v_exp_f32 v110, v110
    v_cvt_pk_bf16_f32 v106, v108, v109
    v_exp_f32 v111, v111
    s_nop 0
    v_cvt_pk_bf16_f32 v107, v110, v111
    v_mfma_f32_16x16x32_bf16 v[76:79], a[112:115], a[0:3], v[44:47]
    v_exp_f32 v70, v70
    v_mfma_f32_16x16x32_bf16 v[76:79], a[116:119], a[4:7], v[76:79]
    v_exp_f32 v69, v69
    v_mfma_f32_16x16x32_bf16 v[76:79], a[120:123], a[8:11], v[76:79]
    v_exp_f32 v68, v68
    v_mfma_f32_16x16x32_bf16 v[76:79], a[124:127], a[12:15], v[76:79]
    ds_write_b64 v18, v[204:205] offset:8192
    v_mfma_f32_16x16x32_bf16 v[192:195], a[128:131], v[100:103], 0
    v_exp_f32 v67, v67
    v_mfma_f32_16x16x32_bf16 v[192:195], a[160:163], v[104:107], v[192:195]
    v_exp_f32 v66, v66
    v_smfmac_f32_16x16x64_bf16 a[236:239], a[224:227], v[100:107], v4
    v_cvt_pk_bf16_f32 v208, v208, v209
    v_mfma_f32_16x16x32_bf16 v[196:199], a[132:135], v[100:103], 0
    v_exp_f32 v65, v65
    v_mfma_f32_16x16x32_bf16 v[196:199], a[164:167], v[104:107], v[196:199]
    buffer_load_dwordx4 v3, s[8:11], s38 offen offset:3072 nt lds
    v_cvt_pk_bf16_f32 v209, v210, v211
    v_mfma_f32_16x16x32_bf16 v[200:203], a[136:139], v[100:103], 0
    s_add_u32 m0, s27, s33
    v_exp_f32 v64, v64
    v_mfma_f32_16x16x32_bf16 v[200:203], a[168:171], v[104:107], v[200:203]
    ds_write_b64 v15, v[208:209] offset:8320
    v_cvt_pk_bf16_f32 v212, v212, v213
    v_cvt_pk_bf16_f32 v213, v214, v215
    v_mfma_f32_16x16x32_bf16 v[204:207], a[140:143], v[100:103], 0
    v_exp_f32 v72, v72
    v_mfma_f32_16x16x32_bf16 v[204:207], a[172:175], v[104:107], v[204:207]
    ds_write_b64 v16, v[212:213] offset:8320
    v_cvt_pk_bf16_f32 v216, v216, v217
    v_cvt_pk_bf16_f32 v217, v218, v219
    v_mfma_f32_16x16x32_bf16 v[208:211], a[144:147], v[100:103], 0
    v_exp_f32 v73, v73
    v_mfma_f32_16x16x32_bf16 v[208:211], a[176:179], v[104:107], v[208:211]
    ds_write_b64 v17, v[216:217] offset:8320
    v_cvt_pk_bf16_f32 v220, v220, v221
    v_cvt_pk_bf16_f32 v221, v222, v223
    v_mfma_f32_16x16x32_bf16 v[212:215], a[148:151], v[100:103], 0
    v_exp_f32 v74, v74
    v_mfma_f32_16x16x32_bf16 v[212:215], a[180:183], v[104:107], v[212:215]
    ds_write_b64 v18, v[220:221] offset:8320
    v_mfma_f32_16x16x32_bf16 v[216:219], a[152:155], v[100:103], 0
    v_exp_f32 v75, v75
    v_mfma_f32_16x16x32_bf16 v[216:219], a[184:187], v[104:107], v[216:219]
    buffer_store_dwordx4 a[212:215], v21, s[20:23], s29 offen offset:1024 nt
    v_mov_b32 v49, v48
    v_mov_b32 v50, v48
    v_mov_b32 v51, v48
    v_mfma_f32_16x16x32_bf16 v[220:223], a[156:159], v[100:103], 0
    v_exp_f32 v76, v76
    v_mfma_f32_16x16x32_bf16 v[220:223], a[188:191], v[104:107], v[220:223]
    v_exp_f32 v77, v77
    v_mfma_f32_16x16x32_bf16 v[84:87], a[64:67], a[16:19], v[48:51]
    v_exp_f32 v78, v78
    v_mfma_f32_16x16x32_bf16 v[84:87], a[68:71], a[20:23], v[84:87]
    v_exp_f32 v79, v79
    v_mfma_f32_16x16x32_bf16 v[84:87], a[72:75], a[24:27], v[84:87]
    v_accvgpr_read_b32 v63, a240
    v_accvgpr_read_b32 v23, a241
    v_mfma_f32_16x16x32_bf16 v[84:87], a[76:79], a[28:31], v[84:87]
    v_add_f32 v63, v63, v23
    v_max3_f32 v24, v112, v113, v114
    v_mfma_f32_16x16x32_bf16 v[80:83], a[80:83], a[16:19], v[48:51]
    v_rcp_f32 v63, v63
    v_mfma_f32_16x16x32_bf16 v[80:83], a[84:87], a[20:23], v[80:83]
    v_max3_f32 v25, v115, v116, v117
    v_max3_f32 v24, v24, v118, v119
    v_mfma_f32_16x16x32_bf16 v[80:83], a[88:91], a[24:27], v[80:83]
    v_exp_f32 v87, v87
    v_mfma_f32_16x16x32_bf16 v[80:83], a[92:95], a[28:31], v[80:83]
    buffer_load_dwordx4 v2, s[12:15], s38 offen offset:0 nt lds
    v_max_f32 v24, v24, v25
    v_mov_b32 v25, v24
    v_pk_mul_f32 v[224:225], v[224:225], v[62:63] op_sel:[0,1] op_sel_hi:[1,1]
    v_pk_mul_f32 v[226:227], v[226:227], v[62:63] op_sel:[0,1] op_sel_hi:[1,1]
    v_pk_mul_f32 v[228:229], v[228:229], v[62:63] op_sel:[0,1] op_sel_hi:[1,1]
    v_pk_mul_f32 v[230:231], v[230:231], v[62:63] op_sel:[0,1] op_sel_hi:[1,1]
    v_pk_mul_f32 v[232:233], v[232:233], v[62:63] op_sel:[0,1] op_sel_hi:[1,1]
    v_pk_mul_f32 v[234:235], v[234:235], v[62:63] op_sel:[0,1] op_sel_hi:[1,1]
    v_pk_mul_f32 v[236:237], v[236:237], v[62:63] op_sel:[0,1] op_sel_hi:[1,1]
    v_pk_mul_f32 v[238:239], v[238:239], v[62:63] op_sel:[0,1] op_sel_hi:[1,1]
    v_pk_mul_f32 v[240:241], v[240:241], v[62:63] op_sel:[0,1] op_sel_hi:[1,1]
    v_pk_mul_f32 v[242:243], v[242:243], v[62:63] op_sel:[0,1] op_sel_hi:[1,1]
    v_pk_mul_f32 v[244:245], v[244:245], v[62:63] op_sel:[0,1] op_sel_hi:[1,1]
    v_pk_mul_f32 v[246:247], v[246:247], v[62:63] op_sel:[0,1] op_sel_hi:[1,1]
    v_pk_mul_f32 v[248:249], v[248:249], v[62:63] op_sel:[0,1] op_sel_hi:[1,1]
    v_pk_mul_f32 v[250:251], v[250:251], v[62:63] op_sel:[0,1] op_sel_hi:[1,1]
    v_pk_mul_f32 v[252:253], v[252:253], v[62:63] op_sel:[0,1] op_sel_hi:[1,1]
    v_pk_mul_f32 v[254:255], v[254:255], v[62:63] op_sel:[0,1] op_sel_hi:[1,1]
    v_mfma_f32_16x16x32_bf16 v[88:91], a[96:99], a[16:19], v[48:51]
    v_permlane32_swap_b32 v24, v25
    v_mfma_f32_16x16x32_bf16 v[88:91], a[100:103], a[20:23], v[88:91]
    v_exp_f32 v86, v86
    v_mfma_f32_16x16x32_bf16 v[88:91], a[104:107], a[24:27], v[88:91]
    v_exp_f32 v85, v85
    v_mfma_f32_16x16x32_bf16 v[88:91], a[108:111], a[28:31], v[88:91]
    v_exp_f32 v84, v84
    v_max_f32 v24, v24, v25
    v_mov_b32 v25, v24
    v_cvt_pk_bf16_f32 v224, v224, v225
    v_cvt_pk_bf16_f32 v228, v228, v229
    v_permlane16_swap_b32 v24, v25
    v_min_f32_e64 v56, -v24, -v25
    v_pk_add_f32 v[112:113], v[112:113], v[56:57] op_sel_hi:[1,0]
    v_pk_add_f32 v[114:115], v[114:115], v[56:57] op_sel_hi:[1,0]
    v_pk_add_f32 v[116:117], v[116:117], v[56:57] op_sel_hi:[1,0]
    v_pk_add_f32 v[118:119], v[118:119], v[56:57] op_sel_hi:[1,0]
    v_pk_add_f32 v[120:121], v[120:121], v[56:57] op_sel_hi:[1,0]
    v_pk_add_f32 v[122:123], v[122:123], v[56:57] op_sel_hi:[1,0]
    v_pk_add_f32 v[124:125], v[124:125], v[56:57] op_sel_hi:[1,0]
    v_pk_add_f32 v[126:127], v[126:127], v[56:57] op_sel_hi:[1,0]
    v_exp_f32 v119, v119
    v_exp_f32 v118, v118
    v_exp_f32 v117, v117
    v_cvt_pk_bf16_f32 v119, v118, v119
    v_cvt_pk_bf16_f32 v225, v226, v227
    v_cvt_pk_bf16_f32 v229, v230, v231
    v_exp_f32 v116, v116
    ds_write_b64 v15, v[224:225] offset:12288
    v_exp_f32 v115, v115
    v_cvt_pk_bf16_f32 v118, v116, v117
    v_exp_f32 v114, v114
    v_exp_f32 v113, v113
    v_cvt_pk_bf16_f32 v117, v114, v115
    v_exp_f32 v112, v112
    v_exp_f32 v120, v120
    v_cvt_pk_bf16_f32 v116, v112, v113
    v_exp_f32 v121, v121
    v_exp_f32 v122, v122
    v_cvt_pk_bf16_f32 v120, v120, v121
    v_exp_f32 v123, v123
    v_exp_f32 v124, v124
    v_cvt_pk_bf16_f32 v121, v122, v123
    v_exp_f32 v125, v125
    v_exp_f32 v126, v126
    v_cvt_pk_bf16_f32 v122, v124, v125
    v_exp_f32 v127, v127
    v_accvgpr_write_b32 a240, 0
    v_cvt_pk_bf16_f32 v123, v126, v127
    v_accvgpr_write_b32 a241, 0
    v_mfma_f32_16x16x32_bf16 v[92:95], a[112:115], a[16:19], v[48:51]
    v_exp_f32 v83, v83
    v_mfma_f32_16x16x32_bf16 v[92:95], a[116:119], a[20:23], v[92:95]
    v_exp_f32 v82, v82
    v_mfma_f32_16x16x32_bf16 v[92:95], a[120:123], a[24:27], v[92:95]
    v_exp_f32 v81, v81
    v_mfma_f32_16x16x32_bf16 v[92:95], a[124:127], a[28:31], v[92:95]
    buffer_store_dwordx4 a[192:195], v21, s[20:23], s29 offen offset:2048 nt
    ds_write_b64 v16, v[228:229] offset:12288
    v_cvt_pk_bf16_f32 v232, v232, v233
    v_cvt_pk_bf16_f32 v233, v234, v235
    v_mfma_f32_16x16x32_bf16 v[224:227], a[128:131], v[116:119], 0
    ds_read_b64_tr_b16 a[128:129], v11 offset:0
    v_cvt_pk_bf16_f32 v236, v236, v237
    v_mfma_f32_16x16x32_bf16 v[224:227], a[160:163], v[120:123], v[224:227]
    ds_write_b64 v17, v[232:233] offset:12288
    v_smfmac_f32_16x16x64_bf16 a[240:243], a[224:227], v[116:123], v4
    ds_read_b64_tr_b16 a[130:131], v11 offset:4096
    ds_read_b64_tr_b16 a[160:161], v11 offset:8192
    v_cvt_pk_bf16_f32 v237, v238, v239
    v_mfma_f32_16x16x32_bf16 v[228:231], a[132:135], v[116:119], 0
    ds_read_b64_tr_b16 a[162:163], v11 offset:12288
    v_cvt_pk_bf16_f32 v240, v240, v241
    v_mfma_f32_16x16x32_bf16 v[228:231], a[164:167], v[120:123], v[228:231]
    ds_write_b64 v18, v[236:237] offset:12288
    v_cvt_pk_bf16_f32 v241, v242, v243
    v_mfma_f32_16x16x32_bf16 v[232:235], a[136:139], v[116:119], 0
    ds_read_b64_tr_b16 a[132:133], v12 offset:0
    v_cvt_pk_bf16_f32 v244, v244, v245
    v_mfma_f32_16x16x32_bf16 v[232:235], a[168:171], v[120:123], v[232:235]
    ds_write_b64 v15, v[240:241] offset:12416
    v_cvt_pk_bf16_f32 v245, v246, v247
    v_mfma_f32_16x16x32_bf16 v[236:239], a[140:143], v[116:119], 0
    ds_read_b64_tr_b16 a[134:135], v12 offset:4096
    v_cvt_pk_bf16_f32 v248, v248, v249
    v_mfma_f32_16x16x32_bf16 v[236:239], a[172:175], v[120:123], v[236:239]
    buffer_load_dwordx4 v3, s[12:15], s38 offen offset:1024 nt lds
    ds_write_b64 v16, v[244:245] offset:12416
    v_cvt_pk_bf16_f32 v249, v250, v251
    v_mfma_f32_16x16x32_bf16 v[240:243], a[144:147], v[116:119], 0
    ds_read_b64_tr_b16 a[164:165], v12 offset:8192
    v_cvt_pk_bf16_f32 v252, v252, v253
    v_mfma_f32_16x16x32_bf16 v[240:243], a[176:179], v[120:123], v[240:243]
    ds_write_b64 v17, v[248:249] offset:12416
    v_cvt_pk_bf16_f32 v253, v254, v255
    v_mfma_f32_16x16x32_bf16 v[244:247], a[148:151], v[116:119], 0
    ds_read_b64_tr_b16 a[166:167], v12 offset:12288
    v_min3_f32 v22, v60, v61, v62
    v_mfma_f32_16x16x32_bf16 v[244:247], a[180:183], v[120:123], v[244:247]
    ds_write_b64 v18, v[252:253] offset:12416
    v_mfma_f32_16x16x32_bf16 v[248:251], a[152:155], v[116:119], 0
    ds_read_b64_tr_b16 a[136:137], v11 offset:256
    v_min_f32 v22, v22, v63
    v_mfma_f32_16x16x32_bf16 v[248:251], a[184:187], v[120:123], v[248:251]
    ds_read_b64_tr_b16 a[138:139], v11 offset:4352
    ds_read_b64_tr_b16 a[168:169], v11 offset:8448
    v_cmp_nlt_f32 vcc, 0x2b800000, v22
    v_mov_b32 v53, v52
    v_mov_b32 v54, v52
    v_mov_b32 v55, v52
    v_mfma_f32_16x16x32_bf16 v[252:255], a[156:159], v[116:119], 0
    s_cmp_lg_u64 vcc, 0
    s_addc_u32 s41, s41, s41
    v_cvt_pk_bf16_f32 v71, v70, v71
    v_mfma_f32_16x16x32_bf16 v[252:255], a[188:191], v[120:123], v[252:255]
    buffer_store_dwordx4 a[196:199], v21, s[20:23], s29 offen offset:3072 nt
    v_mfma_f32_16x16x32_bf16 v[100:103], a[64:67], a[32:35], v[52:55]
    ds_read_b64_tr_b16 a[170:171], v11 offset:12544
    v_cvt_pk_bf16_f32 v70, v68, v69
    v_mfma_f32_16x16x32_bf16 v[100:103], a[68:71], a[36:39], v[100:103]
    ds_read_b64_tr_b16 a[140:141], v12 offset:256
    v_cvt_pk_bf16_f32 v69, v66, v67
    v_mfma_f32_16x16x32_bf16 v[100:103], a[72:75], a[40:43], v[100:103]
    ds_read_b64_tr_b16 a[142:143], v12 offset:4352
    v_cvt_pk_bf16_f32 v68, v64, v65
    v_mfma_f32_16x16x32_bf16 v[100:103], a[76:79], a[44:47], v[100:103]
    ds_read_b64_tr_b16 a[172:173], v12 offset:8448
    ds_read_b64_tr_b16 a[174:175], v12 offset:12544
    v_mfma_f32_16x16x32_bf16 v[96:99], a[80:83], a[32:35], v[52:55]
    s_waitcnt lgkmcnt(9)
    ds_read_b64_tr_b16 a[144:145], v11 offset:512
    v_mfma_f32_16x16x32_bf16 v[96:99], a[84:87], a[36:39], v[96:99]
    ds_read_b64_tr_b16 a[146:147], v11 offset:4608
    v_cvt_pk_bf16_f32 v72, v72, v73
    v_mfma_f32_16x16x32_bf16 v[96:99], a[88:91], a[40:43], v[96:99]
    ds_read_b64_tr_b16 a[176:177], v11 offset:8704
    v_cvt_pk_bf16_f32 v73, v74, v75
    v_mfma_f32_16x16x32_bf16 v[96:99], a[92:95], a[44:47], v[96:99]
    buffer_load_dwordx4 v2, s[12:15], s38 offen offset:2048 nt lds
    v_mfma_f32_16x16x32_bf16 v[104:107], a[96:99], a[32:35], v[52:55]
    ds_read_b64_tr_b16 a[178:179], v11 offset:12800
    v_cvt_pk_bf16_f32 v74, v76, v77
    v_mfma_f32_16x16x32_bf16 v[104:107], a[100:103], a[36:39], v[104:107]
    ds_read_b64_tr_b16 a[148:149], v12 offset:512
    v_cvt_pk_bf16_f32 v75, v78, v79
    v_mfma_f32_16x16x32_bf16 v[104:107], a[104:107], a[40:43], v[104:107]
    ds_read_b64_tr_b16 a[150:151], v12 offset:4608
    v_mov_b32 v57, v56
    v_mfma_f32_16x16x32_bf16 v[104:107], a[108:111], a[44:47], v[104:107]
    ds_read_b64_tr_b16 a[180:181], v12 offset:8704
    ds_read_b64_tr_b16 a[182:183], v12 offset:12800
    v_mfma_f32_16x16x32_bf16 v[108:111], a[112:115], a[32:35], v[52:55]
    s_waitcnt lgkmcnt(8)
    ds_read_b64_tr_b16 a[152:153], v11 offset:768
    v_mfma_f32_16x16x32_bf16 v[108:111], a[116:119], a[36:39], v[108:111]
    ds_read_b64_tr_b16 a[154:155], v11 offset:4864
    v_mov_b32 v58, v56
    v_mfma_f32_16x16x32_bf16 v[108:111], a[120:123], a[40:43], v[108:111]
    ds_read_b64_tr_b16 a[184:185], v11 offset:8960
    v_mov_b32 v59, v56
    v_mfma_f32_16x16x32_bf16 v[108:111], a[124:127], a[44:47], v[108:111]
    ds_read_b64_tr_b16 a[186:187], v11 offset:13056
    ds_read_b64_tr_b16 a[156:157], v12 offset:768
    v_mfma_f32_16x16x32_bf16 v[128:131], a[128:131], v[68:71], v[128:131]
    ds_read_b64_tr_b16 a[158:159], v12 offset:4864
    v_cvt_pk_bf16_f32 v87, v86, v87
    v_mfma_f32_16x16x32_bf16 v[128:131], a[160:163], v[72:75], v[128:131]
    buffer_load_dwordx4 v3, s[12:15], s38 offen offset:3072 nt lds
    v_smfmac_f32_16x16x64_bf16 a[228:231], a[224:227], v[68:75], v4
    ds_read_b64_tr_b16 a[188:189], v12 offset:8960
    v_mfma_f32_16x16x32_bf16 v[132:135], a[132:135], v[68:71], v[132:135]
    ds_read_b64_tr_b16 a[190:191], v12 offset:13056
    v_cvt_pk_bf16_f32 v86, v84, v85
    v_mfma_f32_16x16x32_bf16 v[132:135], a[164:167], v[72:75], v[132:135]
    s_waitcnt lgkmcnt(8)
    v_exp_f32 v103, v103
    v_mfma_f32_16x16x32_bf16 v[136:139], a[136:139], v[68:71], v[136:139]
    s_add_u32 s38, s36, 65536
    v_exp_f32 v102, v102
    v_mfma_f32_16x16x32_bf16 v[136:139], a[168:171], v[72:75], v[136:139]
    s_add_u32 m0, s25, s32
    v_exp_f32 v101, v101
    v_mfma_f32_16x16x32_bf16 v[140:143], a[140:143], v[68:71], v[140:143]
    s_mov_b32 s54, s25
    v_exp_f32 v100, v100
    v_mfma_f32_16x16x32_bf16 v[140:143], a[172:175], v[72:75], v[140:143]
    s_mov_b32 s25, s27
    v_exp_f32 v99, v99
    v_mfma_f32_16x16x32_bf16 v[144:147], a[144:147], v[68:71], v[144:147]
    s_mov_b32 s27, s26
    v_exp_f32 v98, v98
    v_mfma_f32_16x16x32_bf16 v[144:147], a[176:179], v[72:75], v[144:147]
    s_mov_b32 s26, s54
    v_exp_f32 v97, v97
    v_mfma_f32_16x16x32_bf16 v[148:151], a[148:151], v[68:71], v[148:151]
    s_waitcnt lgkmcnt(0)
    v_exp_f32 v80, v80
    v_mfma_f32_16x16x32_bf16 v[148:151], a[180:183], v[72:75], v[148:151]
    s_mov_b32 s35, s36
    v_exp_f32 v96, v96
    v_mfma_f32_16x16x32_bf16 v[152:155], a[152:155], v[68:71], v[152:155]
    s_add_u32 s36, s43, s32
    v_exp_f32 v88, v88
    v_mfma_f32_16x16x32_bf16 v[152:155], a[184:187], v[72:75], v[152:155]
    v_exp_f32 v89, v89
    v_mfma_f32_16x16x32_bf16 v[156:159], a[156:159], v[68:71], v[156:159]
    v_exp_f32 v90, v90
    v_mfma_f32_16x16x32_bf16 v[156:159], a[188:191], v[72:75], v[156:159]
    s_waitcnt vmcnt(14)
    s_barrier
    v_cvt_pk_bf16_f32 v103, v102, v103
    v_cvt_pk_bf16_f32 v102, v100, v101
    v_cvt_pk_bf16_f32 v85, v82, v83
    v_cvt_pk_bf16_f32 v101, v98, v99
    v_cvt_pk_bf16_f32 v84, v80, v81
    v_cvt_pk_bf16_f32 v100, v96, v97
    v_cvt_pk_bf16_f32 v88, v88, v89
    v_exp_f32 v91, v91
    v_exp_f32 v92, v92
    v_cvt_pk_bf16_f32 v89, v90, v91
    v_exp_f32 v93, v93
    v_exp_f32 v94, v94
    v_cvt_pk_bf16_f32 v90, v92, v93
    v_exp_f32 v95, v95
    s_nop 0
    v_cvt_pk_bf16_f32 v91, v94, v95
    s_branch L_U
L_E:
    v_mfma_f32_16x16x32_bf16 v[68:71], a[64:67], a[0:3], v[44:47]
    s_waitcnt lgkmcnt(0)
    v_exp_f32 v116, v116
    v_mfma_f32_16x16x32_bf16 v[68:71], a[68:71], a[4:7], v[68:71]
    v_exp_f32 v115, v115
    v_mfma_f32_16x16x32_bf16 v[68:71], a[72:75], a[8:11], v[68:71]
    v_exp_f32 v114, v114
    v_mfma_f32_16x16x32_bf16 v[68:71], a[76:79], a[12:15], v[68:71]
    v_exp_f32 v113, v113
    v_mfma_f32_16x16x32_bf16 v[64:67], a[80:83], a[0:3], v[44:47]
    v_exp_f32 v112, v112
    v_mfma_f32_16x16x32_bf16 v[64:67], a[84:87], a[4:7], v[64:67]
    v_exp_f32 v120, v120
    v_mfma_f32_16x16x32_bf16 v[64:67], a[88:91], a[8:11], v[64:67]
    v_exp_f32 v121, v121
    v_mfma_f32_16x16x32_bf16 v[64:67], a[92:95], a[12:15], v[64:67]
    v_exp_f32 v122, v122
    v_mfma_f32_16x16x32_bf16 v[72:75], a[96:99], a[0:3], v[44:47]
    v_exp_f32 v123, v123
    v_mfma_f32_16x16x32_bf16 v[72:75], a[100:103], a[4:7], v[72:75]
    v_exp_f32 v124, v124
    v_mfma_f32_16x16x32_bf16 v[72:75], a[104:107], a[8:11], v[72:75]
    v_exp_f32 v125, v125
    v_mfma_f32_16x16x32_bf16 v[72:75], a[108:111], a[12:15], v[72:75]
    v_exp_f32 v126, v126
    v_mfma_f32_16x16x32_bf16 v[76:79], a[112:115], a[0:3], v[44:47]
    v_exp_f32 v127, v127
    v_mfma_f32_16x16x32_bf16 v[76:79], a[116:119], a[4:7], v[76:79]
    v_exp_f32 v71, v71
    v_mfma_f32_16x16x32_bf16 v[76:79], a[120:123], a[8:11], v[76:79]
    v_exp_f32 v70, v70
    v_mfma_f32_16x16x32_bf16 v[76:79], a[124:127], a[12:15], v[76:79]
    v_exp_f32 v69, v69
    v_mfma_f32_16x16x32_bf16 v[192:195], a[128:131], v[100:103], v[192:195]
    v_exp_f32 v68, v68
    v_mfma_f32_16x16x32_bf16 v[192:195], a[160:163], v[104:107], v[192:195]
    v_exp_f32 v67, v67
    v_smfmac_f32_16x16x64_bf16 a[236:239], a[224:227], v[100:107], v4
    v_cvt_pk_bf16_f32 v118, v116, v117
    v_mfma_f32_16x16x32_bf16 v[196:199], a[132:135], v[100:103], v[196:199]
    v_exp_f32 v66, v66
    v_mfma_f32_16x16x32_bf16 v[196:199], a[164:167], v[104:107], v[196:199]
    v_exp_f32 v65, v65
    v_mfma_f32_16x16x32_bf16 v[200:203], a[136:139], v[100:103], v[200:203]
    v_exp_f32 v64, v64
    v_mfma_f32_16x16x32_bf16 v[200:203], a[168:171], v[104:107], v[200:203]
    v_exp_f32 v72, v72
    v_mfma_f32_16x16x32_bf16 v[204:207], a[140:143], v[100:103], v[204:207]
    v_exp_f32 v73, v73
    v_mfma_f32_16x16x32_bf16 v[204:207], a[172:175], v[104:107], v[204:207]
    v_exp_f32 v74, v74
    v_mfma_f32_16x16x32_bf16 v[208:211], a[144:147], v[100:103], v[208:211]
    v_exp_f32 v75, v75
    v_mfma_f32_16x16x32_bf16 v[208:211], a[176:179], v[104:107], v[208:211]
    v_exp_f32 v76, v76
    v_mfma_f32_16x16x32_bf16 v[212:215], a[148:151], v[100:103], v[212:215]
    v_exp_f32 v77, v77
    v_mfma_f32_16x16x32_bf16 v[212:215], a[180:183], v[104:107], v[212:215]
    v_exp_f32 v78, v78
    v_mfma_f32_16x16x32_bf16 v[216:219], a[152:155], v[100:103], v[216:219]
    v_exp_f32 v79, v79
    v_mfma_f32_16x16x32_bf16 v[216:219], a[184:187], v[104:107], v[216:219]
    v_cvt_pk_bf16_f32 v117, v114, v115
    v_cvt_pk_bf16_f32 v116, v112, v113
    v_mfma_f32_16x16x32_bf16 v[220:223], a[156:159], v[100:103], v[220:223]
    v_cvt_pk_bf16_f32 v120, v120, v121
    v_cvt_pk_bf16_f32 v121, v122, v123
    v_cvt_pk_bf16_f32 v122, v124, v125
    v_cvt_pk_bf16_f32 v123, v126, v127
    v_mfma_f32_16x16x32_bf16 v[220:223], a[188:191], v[104:107], v[220:223]
    v_cvt_pk_bf16_f32 v71, v70, v71
    v_cvt_pk_bf16_f32 v70, v68, v69
    v_mfma_f32_16x16x32_bf16 v[224:227], a[128:131], v[116:119], v[224:227]
    ds_read_b64_tr_b16 a[128:129], v11 offset:0
    v_cvt_pk_bf16_f32 v69, v66, v67
    v_mfma_f32_16x16x32_bf16 v[224:227], a[160:163], v[120:123], v[224:227]
    ds_read_b64_tr_b16 a[130:131], v11 offset:4096
    v_cvt_pk_bf16_f32 v68, v64, v65
    v_smfmac_f32_16x16x64_bf16 a[240:243], a[224:227], v[116:123], v4
    ds_read_b64_tr_b16 a[160:161], v11 offset:8192
    v_mfma_f32_16x16x32_bf16 v[228:231], a[132:135], v[116:119], v[228:231]
    ds_read_b64_tr_b16 a[162:163], v11 offset:12288
    v_cvt_pk_bf16_f32 v72, v72, v73
    v_mfma_f32_16x16x32_bf16 v[228:231], a[164:167], v[120:123], v[228:231]
    ds_read_b64_tr_b16 a[132:133], v12 offset:0
    v_cvt_pk_bf16_f32 v73, v74, v75
    v_mfma_f32_16x16x32_bf16 v[232:235], a[136:139], v[116:119], v[232:235]
    ds_read_b64_tr_b16 a[134:135], v12 offset:4096
    v_cvt_pk_bf16_f32 v74, v76, v77
    v_mfma_f32_16x16x32_bf16 v[232:235], a[168:171], v[120:123], v[232:235]
    ds_read_b64_tr_b16 a[164:165], v12 offset:8192
    v_cvt_pk_bf16_f32 v75, v78, v79
    v_mfma_f32_16x16x32_bf16 v[236:239], a[140:143], v[116:119], v[236:239]
    ds_read_b64_tr_b16 a[166:167], v12 offset:12288
    v_mfma_f32_16x16x32_bf16 v[236:239], a[172:175], v[120:123], v[236:239]
    ds_read_b64_tr_b16 a[136:137], v11 offset:256
    v_mfma_f32_16x16x32_bf16 v[240:243], a[144:147], v[116:119], v[240:243]
    ds_read_b64_tr_b16 a[138:139], v11 offset:4352
    v_mfma_f32_16x16x32_bf16 v[240:243], a[176:179], v[120:123], v[240:243]
    ds_read_b64_tr_b16 a[168:169], v11 offset:8448
    v_mfma_f32_16x16x32_bf16 v[244:247], a[148:151], v[116:119], v[244:247]
    ds_read_b64_tr_b16 a[170:171], v11 offset:12544
    v_mfma_f32_16x16x32_bf16 v[244:247], a[180:183], v[120:123], v[244:247]
    ds_read_b64_tr_b16 a[140:141], v12 offset:256
    v_mfma_f32_16x16x32_bf16 v[248:251], a[152:155], v[116:119], v[248:251]
    ds_read_b64_tr_b16 a[142:143], v12 offset:4352
    v_mfma_f32_16x16x32_bf16 v[248:251], a[184:187], v[120:123], v[248:251]
    ds_read_b64_tr_b16 a[172:173], v12 offset:8448
    v_mfma_f32_16x16x32_bf16 v[252:255], a[156:159], v[116:119], v[252:255]
    ds_read_b64_tr_b16 a[174:175], v12 offset:12544
    v_mfma_f32_16x16x32_bf16 v[252:255], a[188:191], v[120:123], v[252:255]
    s_waitcnt vmcnt(0)
    v_mfma_f32_16x16x32_bf16 v[84:87], a[64:67], a[16:19], v[48:51]
    s_waitcnt lgkmcnt(8)
    v_mfma_f32_16x16x32_bf16 v[84:87], a[68:71], a[20:23], v[84:87]
    ds_read_b64_tr_b16 a[144:145], v11 offset:512
    v_mfma_f32_16x16x32_bf16 v[84:87], a[72:75], a[24:27], v[84:87]
    ds_read_b64_tr_b16 a[146:147], v11 offset:4608
    v_mfma_f32_16x16x32_bf16 v[84:87], a[76:79], a[28:31], v[84:87]
    ds_read_b64_tr_b16 a[176:177], v11 offset:8704
    v_mfma_f32_16x16x32_bf16 v[80:83], a[80:83], a[16:19], v[48:51]
    ds_read_b64_tr_b16 a[178:179], v11 offset:12800
    v_mfma_f32_16x16x32_bf16 v[80:83], a[84:87], a[20:23], v[80:83]
    ds_read_b64_tr_b16 a[148:149], v12 offset:512
    v_mfma_f32_16x16x32_bf16 v[80:83], a[88:91], a[24:27], v[80:83]
    ds_read_b64_tr_b16 a[150:151], v12 offset:4608
    v_exp_f32 v87, v87
    v_mfma_f32_16x16x32_bf16 v[80:83], a[92:95], a[28:31], v[80:83]
    ds_read_b64_tr_b16 a[180:181], v12 offset:8704
    v_exp_f32 v86, v86
    v_mfma_f32_16x16x32_bf16 v[88:91], a[96:99], a[16:19], v[48:51]
    ds_read_b64_tr_b16 a[182:183], v12 offset:12800
    v_cvt_pk_bf16_f32 v87, v86, v87
    v_mfma_f32_16x16x32_bf16 v[88:91], a[100:103], a[20:23], v[88:91]
    s_waitcnt lgkmcnt(8)
    v_exp_f32 v85, v85
    v_mfma_f32_16x16x32_bf16 v[88:91], a[104:107], a[24:27], v[88:91]
    ds_read_b64_tr_b16 a[152:153], v11 offset:768
    v_exp_f32 v84, v84
    v_mfma_f32_16x16x32_bf16 v[88:91], a[108:111], a[28:31], v[88:91]
    ds_read_b64_tr_b16 a[154:155], v11 offset:4864
    v_cvt_pk_bf16_f32 v86, v84, v85
    v_mfma_f32_16x16x32_bf16 v[92:95], a[112:115], a[16:19], v[48:51]
    ds_read_b64_tr_b16 a[184:185], v11 offset:8960
    v_exp_f32 v83, v83
    v_mfma_f32_16x16x32_bf16 v[92:95], a[116:119], a[20:23], v[92:95]
    ds_read_b64_tr_b16 a[186:187], v11 offset:13056
    v_exp_f32 v82, v82
    v_mfma_f32_16x16x32_bf16 v[92:95], a[120:123], a[24:27], v[92:95]
    ds_read_b64_tr_b16 a[156:157], v12 offset:768
    v_cvt_pk_bf16_f32 v85, v82, v83
    v_mfma_f32_16x16x32_bf16 v[92:95], a[124:127], a[28:31], v[92:95]
    ds_read_b64_tr_b16 a[158:159], v12 offset:4864
    v_exp_f32 v81, v81
    v_smfmac_f32_16x16x64_bf16 a[228:231], a[224:227], v[68:75], v4
    ds_read_b64_tr_b16 a[188:189], v12 offset:8960
    v_mfma_f32_16x16x32_bf16 v[128:131], a[128:131], v[68:71], v[128:131]
    ds_read_b64_tr_b16 a[190:191], v12 offset:13056
    v_exp_f32 v80, v80
    v_mfma_f32_16x16x32_bf16 v[128:131], a[160:163], v[72:75], v[128:131]
    s_waitcnt lgkmcnt(8)
    v_exp_f32 v88, v88
    v_mfma_f32_16x16x32_bf16 v[132:135], a[132:135], v[68:71], v[132:135]
    v_exp_f32 v89, v89
    v_mfma_f32_16x16x32_bf16 v[132:135], a[164:167], v[72:75], v[132:135]
    v_exp_f32 v90, v90
    v_mfma_f32_16x16x32_bf16 v[136:139], a[136:139], v[68:71], v[136:139]
    v_exp_f32 v91, v91
    v_accvgpr_read_b32 v60, a228
    v_accvgpr_read_b32 v5, a229
    v_add_f32 v60, v60, v5
    v_rcp_f32 v60, v60
    v_mfma_f32_16x16x32_bf16 v[136:139], a[168:171], v[72:75], v[136:139]
    v_exp_f32 v92, v92
    v_mfma_f32_16x16x32_bf16 v[140:143], a[140:143], v[68:71], v[140:143]
    v_exp_f32 v93, v93
    v_mfma_f32_16x16x32_bf16 v[140:143], a[172:175], v[72:75], v[140:143]
    v_exp_f32 v94, v94
    v_mfma_f32_16x16x32_bf16 v[144:147], a[144:147], v[68:71], v[144:147]
    s_waitcnt lgkmcnt(0)
    v_exp_f32 v95, v95
    v_mfma_f32_16x16x32_bf16 v[144:147], a[176:179], v[72:75], v[144:147]
    v_cvt_pk_bf16_f32 v84, v80, v81
    v_cvt_pk_bf16_f32 v88, v88, v89
    v_mfma_f32_16x16x32_bf16 v[148:151], a[148:151], v[68:71], v[148:151]
    v_cvt_pk_bf16_f32 v89, v90, v91
    v_cvt_pk_bf16_f32 v90, v92, v93
    v_cvt_pk_bf16_f32 v91, v94, v95
    v_mfma_f32_16x16x32_bf16 v[148:151], a[180:183], v[72:75], v[148:151]
    v_pk_mul_f32 v[128:129], v[128:129], v[60:61] op_sel_hi:[1,0]
    v_pk_mul_f32 v[130:131], v[130:131], v[60:61] op_sel_hi:[1,0]
    v_pk_mul_f32 v[132:133], v[132:133], v[60:61] op_sel_hi:[1,0]
    v_pk_mul_f32 v[134:135], v[134:135], v[60:61] op_sel_hi:[1,0]
    v_pk_mul_f32 v[136:137], v[136:137], v[60:61] op_sel_hi:[1,0]
    v_pk_mul_f32 v[138:139], v[138:139], v[60:61] op_sel_hi:[1,0]
    v_pk_mul_f32 v[140:141], v[140:141], v[60:61] op_sel_hi:[1,0]
    v_pk_mul_f32 v[142:143], v[142:143], v[60:61] op_sel_hi:[1,0]
    v_mfma_f32_16x16x32_bf16 v[152:155], a[152:155], v[68:71], v[152:155]
    v_cvt_pk_bf16_f32 v128, v128, v129
    v_cvt_pk_bf16_f32 v129, v130, v131
    v_mfma_f32_16x16x32_bf16 v[152:155], a[184:187], v[72:75], v[152:155]
    ds_write_b64 v15, v[128:129] offset:0
    v_mfma_f32_16x16x32_bf16 v[156:159], a[156:159], v[68:71], v[156:159]
    v_cvt_pk_bf16_f32 v132, v132, v133
    v_cvt_pk_bf16_f32 v133, v134, v135
    v_mfma_f32_16x16x32_bf16 v[156:159], a[188:191], v[72:75], v[156:159]
    ds_write_b64 v16, v[132:133] offset:0
    v_mfma_f32_16x16x32_bf16 v[100:103], a[64:67], a[32:35], v[52:55]
    v_cvt_pk_bf16_f32 v136, v136, v137
    v_cvt_pk_bf16_f32 v137, v138, v139
    v_mfma_f32_16x16x32_bf16 v[100:103], a[68:71], a[36:39], v[100:103]
    ds_write_b64 v17, v[136:137] offset:0
    v_mfma_f32_16x16x32_bf16 v[100:103], a[72:75], a[40:43], v[100:103]
    v_cvt_pk_bf16_f32 v140, v140, v141
    v_cvt_pk_bf16_f32 v141, v142, v143
    v_mfma_f32_16x16x32_bf16 v[100:103], a[76:79], a[44:47], v[100:103]
    ds_write_b64 v18, v[140:141] offset:0
    v_pk_mul_f32 v[144:145], v[144:145], v[60:61] op_sel_hi:[1,0]
    v_pk_mul_f32 v[146:147], v[146:147], v[60:61] op_sel_hi:[1,0]
    v_pk_mul_f32 v[148:149], v[148:149], v[60:61] op_sel_hi:[1,0]
    v_pk_mul_f32 v[150:151], v[150:151], v[60:61] op_sel_hi:[1,0]
    v_pk_mul_f32 v[152:153], v[152:153], v[60:61] op_sel_hi:[1,0]
    v_pk_mul_f32 v[154:155], v[154:155], v[60:61] op_sel_hi:[1,0]
    v_pk_mul_f32 v[156:157], v[156:157], v[60:61] op_sel_hi:[1,0]
    v_pk_mul_f32 v[158:159], v[158:159], v[60:61] op_sel_hi:[1,0]
    v_mfma_f32_16x16x32_bf16 v[96:99], a[80:83], a[32:35], v[52:55]
    v_cvt_pk_bf16_f32 v144, v144, v145
    v_cvt_pk_bf16_f32 v145, v146, v147
    v_mfma_f32_16x16x32_bf16 v[96:99], a[84:87], a[36:39], v[96:99]
    ds_write_b64 v15, v[144:145] offset:128
    v_mfma_f32_16x16x32_bf16 v[96:99], a[88:91], a[40:43], v[96:99]
    v_exp_f32 v103, v103
    v_cvt_pk_bf16_f32 v148, v148, v149
    v_cvt_pk_bf16_f32 v149, v150, v151
    v_mfma_f32_16x16x32_bf16 v[96:99], a[92:95], a[44:47], v[96:99]
    ds_write_b64 v16, v[148:149] offset:128
    v_mfma_f32_16x16x32_bf16 v[104:107], a[96:99], a[32:35], v[52:55]
    v_exp_f32 v102, v102
    v_cvt_pk_bf16_f32 v152, v152, v153
    v_cvt_pk_bf16_f32 v153, v154, v155
    v_mfma_f32_16x16x32_bf16 v[104:107], a[100:103], a[36:39], v[104:107]
    ds_write_b64 v17, v[152:153] offset:128
    v_mfma_f32_16x16x32_bf16 v[104:107], a[104:107], a[40:43], v[104:107]
    v_exp_f32 v101, v101
    v_cvt_pk_bf16_f32 v156, v156, v157
    v_cvt_pk_bf16_f32 v157, v158, v159
    v_mfma_f32_16x16x32_bf16 v[104:107], a[108:111], a[44:47], v[104:107]
    ds_write_b64 v18, v[156:157] offset:128
    v_mfma_f32_16x16x32_bf16 v[108:111], a[112:115], a[32:35], v[52:55]
    ds_read_b128 a[192:195], v19 offset:0
    v_cvt_pk_bf16_f32 v103, v102, v103
    v_mfma_f32_16x16x32_bf16 v[108:111], a[116:119], a[36:39], v[108:111]
    ds_read_b128 a[196:199], v20 offset:1024
    v_exp_f32 v100, v100
    v_mfma_f32_16x16x32_bf16 v[108:111], a[120:123], a[40:43], v[108:111]
    ds_read_b128 a[200:203], v19 offset:2048
    v_cvt_pk_bf16_f32 v102, v100, v101
    v_mfma_f32_16x16x32_bf16 v[108:111], a[124:127], a[44:47], v[108:111]
    ds_read_b128 a[204:207], v20 offset:3072
    v_exp_f32 v99, v99
    v_smfmac_f32_16x16x64_bf16 a[232:235], a[224:227], v[84:91], v4
    v_exp_f32 v98, v98
    v_mfma_f32_16x16x32_bf16 v[160:163], a[128:131], v[84:87], v[160:163]
    v_exp_f32 v97, v97
    v_mfma_f32_16x16x32_bf16 v[160:163], a[160:163], v[88:91], v[160:163]
    v_exp_f32 v96, v96
    v_mfma_f32_16x16x32_bf16 v[164:167], a[132:135], v[84:87], v[164:167]
    v_exp_f32 v104, v104
    v_mfma_f32_16x16x32_bf16 v[164:167], a[164:167], v[88:91], v[164:167]
    s_waitcnt lgkmcnt(3)
    buffer_store_dwordx4 a[192:195], v21, s[20:23], s28 offen offset:0 nt
    v_mfma_f32_16x16x32_bf16 v[168:171], a[136:139], v[84:87], v[168:171]
    v_exp_f32 v105, v105
    v_accvgpr_read_b32 v61, a232
    v_accvgpr_read_b32 v6, a233
    v_add_f32 v61, v61, v6
    v_rcp_f32 v61, v61
    v_mfma_f32_16x16x32_bf16 v[168:171], a[168:171], v[88:91], v[168:171]
    s_waitcnt lgkmcnt(2)
    buffer_store_dwordx4 a[196:199], v21, s[20:23], s28 offen offset:1024 nt
    v_mfma_f32_16x16x32_bf16 v[172:175], a[140:143], v[84:87], v[172:175]
    v_exp_f32 v106, v106
    v_mfma_f32_16x16x32_bf16 v[172:175], a[172:175], v[88:91], v[172:175]
    s_waitcnt lgkmcnt(1)
    buffer_store_dwordx4 a[200:203], v21, s[20:23], s28 offen offset:2048 nt
    v_mfma_f32_16x16x32_bf16 v[176:179], a[144:147], v[84:87], v[176:179]
    v_exp_f32 v107, v107
    v_mfma_f32_16x16x32_bf16 v[176:179], a[176:179], v[88:91], v[176:179]
    s_waitcnt lgkmcnt(0)
    buffer_store_dwordx4 a[204:207], v21, s[20:23], s28 offen offset:3072 nt
    v_mfma_f32_16x16x32_bf16 v[180:183], a[148:151], v[84:87], v[180:183]
    v_cvt_pk_bf16_f32 v101, v98, v99
    v_cvt_pk_bf16_f32 v100, v96, v97
    v_cvt_pk_bf16_f32 v104, v104, v105
    v_exp_f32 v108, v108
    v_pk_mul_f32 v[160:161], v[160:161], v[60:61] op_sel:[0,1] op_sel_hi:[1,1]
    v_pk_mul_f32 v[162:163], v[162:163], v[60:61] op_sel:[0,1] op_sel_hi:[1,1]
    v_pk_mul_f32 v[164:165], v[164:165], v[60:61] op_sel:[0,1] op_sel_hi:[1,1]
    v_pk_mul_f32 v[166:167], v[166:167], v[60:61] op_sel:[0,1] op_sel_hi:[1,1]
    v_pk_mul_f32 v[168:169], v[168:169], v[60:61] op_sel:[0,1] op_sel_hi:[1,1]
    v_pk_mul_f32 v[170:171], v[170:171], v[60:61] op_sel:[0,1] op_sel_hi:[1,1]
    v_pk_mul_f32 v[172:173], v[172:173], v[60:61] op_sel:[0,1] op_sel_hi:[1,1]
    v_pk_mul_f32 v[174:175], v[174:175], v[60:61] op_sel:[0,1] op_sel_hi:[1,1]
    v_mfma_f32_16x16x32_bf16 v[180:183], a[180:183], v[88:91], v[180:183]
    v_exp_f32 v109, v109
    v_mfma_f32_16x16x32_bf16 v[184:187], a[152:155], v[84:87], v[184:187]
    v_exp_f32 v110, v110
    v_cvt_pk_bf16_f32 v160, v160, v161
    v_cvt_pk_bf16_f32 v161, v162, v163
    v_cvt_pk_bf16_f32 v105, v106, v107
    v_cvt_pk_bf16_f32 v106, v108, v109
    v_exp_f32 v111, v111
    s_nop 0
    v_cvt_pk_bf16_f32 v107, v110, v111
    v_mfma_f32_16x16x32_bf16 v[184:187], a[184:187], v[88:91], v[184:187]
    ds_write_b64 v15, v[160:161] offset:4096
    v_mfma_f32_16x16x32_bf16 v[188:191], a[156:159], v[84:87], v[188:191]
    v_cvt_pk_bf16_f32 v164, v164, v165
    v_cvt_pk_bf16_f32 v165, v166, v167
    v_mfma_f32_16x16x32_bf16 v[188:191], a[188:191], v[88:91], v[188:191]
    ds_write_b64 v16, v[164:165] offset:4096
    v_smfmac_f32_16x16x64_bf16 a[236:239], a[224:227], v[100:107], v4
    v_cvt_pk_bf16_f32 v168, v168, v169
    v_mfma_f32_16x16x32_bf16 v[192:195], a[128:131], v[100:103], v[192:195]
    v_cvt_pk_bf16_f32 v169, v170, v171
    v_cvt_pk_bf16_f32 v172, v172, v173
    v_mfma_f32_16x16x32_bf16 v[192:195], a[160:163], v[104:107], v[192:195]
    ds_write_b64 v17, v[168:169] offset:4096
    v_mfma_f32_16x16x32_bf16 v[196:199], a[132:135], v[100:103], v[196:199]
    v_cvt_pk_bf16_f32 v173, v174, v175
    v_mfma_f32_16x16x32_bf16 v[196:199], a[164:167], v[104:107], v[196:199]
    ds_write_b64 v18, v[172:173] offset:4096
    v_accvgpr_read_b32 v62, a236
    v_accvgpr_read_b32 v14, a237
    v_pk_mul_f32 v[176:177], v[176:177], v[60:61] op_sel:[0,1] op_sel_hi:[1,1]
    v_pk_mul_f32 v[178:179], v[178:179], v[60:61] op_sel:[0,1] op_sel_hi:[1,1]
    v_pk_mul_f32 v[180:181], v[180:181], v[60:61] op_sel:[0,1] op_sel_hi:[1,1]
    v_pk_mul_f32 v[182:183], v[182:183], v[60:61] op_sel:[0,1] op_sel_hi:[1,1]
    v_pk_mul_f32 v[184:185], v[184:185], v[60:61] op_sel:[0,1] op_sel_hi:[1,1]
    v_pk_mul_f32 v[186:187], v[186:187], v[60:61] op_sel:[0,1] op_sel_hi:[1,1]
    v_pk_mul_f32 v[188:189], v[188:189], v[60:61] op_sel:[0,1] op_sel_hi:[1,1]
    v_pk_mul_f32 v[190:191], v[190:191], v[60:61] op_sel:[0,1] op_sel_hi:[1,1]
    v_mfma_f32_16x16x32_bf16 v[200:203], a[136:139], v[100:103], v[200:203]
    v_add_f32 v62, v62, v14
    v_cvt_pk_bf16_f32 v176, v176, v177
    v_rcp_f32 v62, v62
    v_cvt_pk_bf16_f32 v177, v178, v179
    v_mfma_f32_16x16x32_bf16 v[200:203], a[168:171], v[104:107], v[200:203]
    ds_write_b64 v15, v[176:177] offset:4224
    v_mfma_f32_16x16x32_bf16 v[204:207], a[140:143], v[100:103], v[204:207]
    v_cvt_pk_bf16_f32 v180, v180, v181
    v_cvt_pk_bf16_f32 v181, v182, v183
    v_mfma_f32_16x16x32_bf16 v[204:207], a[172:175], v[104:107], v[204:207]
    ds_write_b64 v16, v[180:181] offset:4224
    v_mfma_f32_16x16x32_bf16 v[208:211], a[144:147], v[100:103], v[208:211]
    v_cvt_pk_bf16_f32 v184, v184, v185
    v_cvt_pk_bf16_f32 v185, v186, v187
    v_mfma_f32_16x16x32_bf16 v[208:211], a[176:179], v[104:107], v[208:211]
    ds_write_b64 v17, v[184:185] offset:4224
    v_mfma_f32_16x16x32_bf16 v[212:215], a[148:151], v[100:103], v[212:215]
    v_cvt_pk_bf16_f32 v188, v188, v189
    v_cvt_pk_bf16_f32 v189, v190, v191
    v_mfma_f32_16x16x32_bf16 v[212:215], a[180:183], v[104:107], v[212:215]
    ds_write_b64 v18, v[188:189] offset:4224
    v_pk_mul_f32 v[192:193], v[192:193], v[62:63] op_sel_hi:[1,0]
    v_pk_mul_f32 v[194:195], v[194:195], v[62:63] op_sel_hi:[1,0]
    v_pk_mul_f32 v[196:197], v[196:197], v[62:63] op_sel_hi:[1,0]
    v_pk_mul_f32 v[198:199], v[198:199], v[62:63] op_sel_hi:[1,0]
    v_pk_mul_f32 v[200:201], v[200:201], v[62:63] op_sel_hi:[1,0]
    v_pk_mul_f32 v[202:203], v[202:203], v[62:63] op_sel_hi:[1,0]
    v_pk_mul_f32 v[204:205], v[204:205], v[62:63] op_sel_hi:[1,0]
    v_pk_mul_f32 v[206:207], v[206:207], v[62:63] op_sel_hi:[1,0]
    v_mfma_f32_16x16x32_bf16 v[216:219], a[152:155], v[100:103], v[216:219]
    ds_read_b128 a[208:211], v19 offset:4096
    ds_read_b128 a[212:215], v20 offset:5120
    v_cvt_pk_bf16_f32 v192, v192, v193
    v_cvt_pk_bf16_f32 v193, v194, v195
    v_mfma_f32_16x16x32_bf16 v[216:219], a[184:187], v[104:107], v[216:219]
    ds_write_b64 v15, v[192:193] offset:8192
    v_mfma_f32_16x16x32_bf16 v[220:223], a[156:159], v[100:103], v[220:223]
    ds_read_b128 a[192:195], v19 offset:6144
    ds_read_b128 a[196:199], v20 offset:7168
    v_cvt_pk_bf16_f32 v196, v196, v197
    v_cvt_pk_bf16_f32 v197, v198, v199
    v_mfma_f32_16x16x32_bf16 v[220:223], a[188:191], v[104:107], v[220:223]
    ds_write_b64 v16, v[196:197] offset:8192
    v_mfma_f32_16x16x32_bf16 v[116:119], a[64:67], a[48:51], v[56:59]
    v_cvt_pk_bf16_f32 v200, v200, v201
    v_cvt_pk_bf16_f32 v201, v202, v203
    v_mfma_f32_16x16x32_bf16 v[116:119], a[68:71], a[52:55], v[116:119]
    ds_write_b64 v17, v[200:201] offset:8192
    v_mfma_f32_16x16x32_bf16 v[116:119], a[72:75], a[56:59], v[116:119]
    v_cvt_pk_bf16_f32 v204, v204, v205
    v_cvt_pk_bf16_f32 v205, v206, v207
    v_mfma_f32_16x16x32_bf16 v[116:119], a[76:79], a[60:63], v[116:119]
    ds_write_b64 v18, v[204:205] offset:8192
    v_pk_mul_f32 v[208:209], v[208:209], v[62:63] op_sel_hi:[1,0]
    v_pk_mul_f32 v[210:211], v[210:211], v[62:63] op_sel_hi:[1,0]
    v_pk_mul_f32 v[212:213], v[212:213], v[62:63] op_sel_hi:[1,0]
    v_pk_mul_f32 v[214:215], v[214:215], v[62:63] op_sel_hi:[1,0]
    v_pk_mul_f32 v[216:217], v[216:217], v[62:63] op_sel_hi:[1,0]
    v_pk_mul_f32 v[218:219], v[218:219], v[62:63] op_sel_hi:[1,0]
    v_pk_mul_f32 v[220:221], v[220:221], v[62:63] op_sel_hi:[1,0]
    v_pk_mul_f32 v[222:223], v[222:223], v[62:63] op_sel_hi:[1,0]
    v_mfma_f32_16x16x32_bf16 v[112:115], a[80:83], a[48:51], v[56:59]
    s_waitcnt lgkmcnt(7)
    buffer_store_dwordx4 a[208:211], v21, s[20:23], s29 offen offset:0 nt
    v_cvt_pk_bf16_f32 v208, v208, v209
    v_cvt_pk_bf16_f32 v209, v210, v211
    v_mfma_f32_16x16x32_bf16 v[112:115], a[84:87], a[52:55], v[112:115]
    ds_write_b64 v15, v[208:209] offset:8320
    v_mfma_f32_16x16x32_bf16 v[112:115], a[88:91], a[56:59], v[112:115]
    s_waitcnt lgkmcnt(7)
    buffer_store_dwordx4 a[212:215], v21, s[20:23], s29 offen offset:1024 nt
    v_cvt_pk_bf16_f32 v212, v212, v213
    v_cvt_pk_bf16_f32 v213, v214, v215
    v_mfma_f32_16x16x32_bf16 v[112:115], a[92:95], a[60:63], v[112:115]
    ds_write_b64 v16, v[212:213] offset:8320
    v_mfma_f32_16x16x32_bf16 v[120:123], a[96:99], a[48:51], v[56:59]
    s_waitcnt lgkmcnt(6)
    buffer_store_dwordx4 a[192:195], v21, s[20:23], s29 offen offset:2048 nt
    v_cvt_pk_bf16_f32 v216, v216, v217
    v_cvt_pk_bf16_f32 v217, v218, v219
    v_mfma_f32_16x16x32_bf16 v[120:123], a[100:103], a[52:55], v[120:123]
    ds_write_b64 v17, v[216:217] offset:8320
    v_mfma_f32_16x16x32_bf16 v[120:123], a[104:107], a[56:59], v[120:123]
    s_waitcnt lgkmcnt(6)
    buffer_store_dwordx4 a[196:199], v21, s[20:23], s29 offen offset:3072 nt
    v_cvt_pk_bf16_f32 v220, v220, v221
    v_cvt_pk_bf16_f32 v221, v222, v223
    v_mfma_f32_16x16x32_bf16 v[120:123], a[108:111], a[60:63], v[120:123]
    ds_write_b64 v18, v[220:221] offset:8320
    v_mfma_f32_16x16x32_bf16 v[124:127], a[112:115], a[48:51], v[56:59]
    ds_read_b128 a[200:203], v19 offset:8192
    v_exp_f32 v119, v119
    v_mfma_f32_16x16x32_bf16 v[124:127], a[116:119], a[52:55], v[124:127]
    ds_read_b128 a[204:207], v20 offset:9216
    v_exp_f32 v118, v118
    v_mfma_f32_16x16x32_bf16 v[124:127], a[120:123], a[56:59], v[124:127]
    ds_read_b128 a[208:211], v19 offset:10240
    v_cvt_pk_bf16_f32 v119, v118, v119
    v_mfma_f32_16x16x32_bf16 v[124:127], a[124:127], a[60:63], v[124:127]
    ds_read_b128 a[212:215], v20 offset:11264
    v_exp_f32 v117, v117
    v_exp_f32 v116, v116
    v_exp_f32 v115, v115
    v_cvt_pk_bf16_f32 v118, v116, v117
    v_exp_f32 v114, v114
    v_exp_f32 v113, v113
    v_cvt_pk_bf16_f32 v117, v114, v115
    v_exp_f32 v112, v112
    v_exp_f32 v120, v120
    v_cvt_pk_bf16_f32 v116, v112, v113
    v_exp_f32 v121, v121
    v_exp_f32 v122, v122
    v_cvt_pk_bf16_f32 v120, v120, v121
    v_exp_f32 v123, v123
    v_exp_f32 v124, v124
    v_cvt_pk_bf16_f32 v121, v122, v123
    v_exp_f32 v125, v125
    v_exp_f32 v126, v126
    v_cvt_pk_bf16_f32 v122, v124, v125
    v_exp_f32 v127, v127
    s_nop 0
    v_cvt_pk_bf16_f32 v123, v126, v127
    s_waitcnt lgkmcnt(3)
    buffer_store_dwordx4 a[200:203], v21, s[20:23], s30 offen offset:0 nt
    v_smfmac_f32_16x16x64_bf16 a[240:243], a[224:227], v[116:123], v4
    s_waitcnt lgkmcnt(2)
    buffer_store_dwordx4 a[204:207], v21, s[20:23], s30 offen offset:1024 nt
    v_mfma_f32_16x16x32_bf16 v[224:227], a[128:131], v[116:119], v[224:227]
    v_mfma_f32_16x16x32_bf16 v[224:227], a[160:163], v[120:123], v[224:227]
    s_waitcnt lgkmcnt(1)
    buffer_store_dwordx4 a[208:211], v21, s[20:23], s30 offen offset:2048 nt
    v_mfma_f32_16x16x32_bf16 v[228:231], a[132:135], v[116:119], v[228:231]
    v_mfma_f32_16x16x32_bf16 v[228:231], a[164:167], v[120:123], v[228:231]
    s_waitcnt lgkmcnt(0)
    buffer_store_dwordx4 a[212:215], v21, s[20:23], s30 offen offset:3072 nt
    v_mfma_f32_16x16x32_bf16 v[232:235], a[136:139], v[116:119], v[232:235]
    v_accvgpr_read_b32 v63, a240
    v_accvgpr_read_b32 v23, a241
    v_mfma_f32_16x16x32_bf16 v[232:235], a[168:171], v[120:123], v[232:235]
    v_add_f32 v63, v63, v23
    v_mfma_f32_16x16x32_bf16 v[236:239], a[140:143], v[116:119], v[236:239]
    v_rcp_f32 v63, v63
    v_mfma_f32_16x16x32_bf16 v[236:239], a[172:175], v[120:123], v[236:239]
    v_min3_f32 v22, v60, v61, v62
    v_min_f32 v22, v22, v63
    v_mfma_f32_16x16x32_bf16 v[240:243], a[144:147], v[116:119], v[240:243]
    v_cmp_nlt_f32 vcc, 0x2b800000, v22
    v_mfma_f32_16x16x32_bf16 v[240:243], a[176:179], v[120:123], v[240:243]
    s_cmp_lg_u64 vcc, 0
    s_addc_u32 s41, s41, s41
    v_mfma_f32_16x16x32_bf16 v[244:247], a[148:151], v[116:119], v[244:247]
    v_mfma_f32_16x16x32_bf16 v[244:247], a[180:183], v[120:123], v[244:247]
    v_mfma_f32_16x16x32_bf16 v[248:251], a[152:155], v[116:119], v[248:251]
    v_mfma_f32_16x16x32_bf16 v[248:251], a[184:187], v[120:123], v[248:251]
    v_mfma_f32_16x16x32_bf16 v[252:255], a[156:159], v[116:119], v[252:255]
    v_mfma_f32_16x16x32_bf16 v[252:255], a[188:191], v[120:123], v[252:255]
    v_pk_mul_f32 v[224:225], v[224:225], v[62:63] op_sel:[0,1] op_sel_hi:[1,1]
    v_pk_mul_f32 v[226:227], v[226:227], v[62:63] op_sel:[0,1] op_sel_hi:[1,1]
    v_pk_mul_f32 v[228:229], v[228:229], v[62:63] op_sel:[0,1] op_sel_hi:[1,1]
    v_pk_mul_f32 v[230:231], v[230:231], v[62:63] op_sel:[0,1] op_sel_hi:[1,1]
    v_pk_mul_f32 v[232:233], v[232:233], v[62:63] op_sel:[0,1] op_sel_hi:[1,1]
    v_pk_mul_f32 v[234:235], v[234:235], v[62:63] op_sel:[0,1] op_sel_hi:[1,1]
    v_pk_mul_f32 v[236:237], v[236:237], v[62:63] op_sel:[0,1] op_sel_hi:[1,1]
    v_pk_mul_f32 v[238:239], v[238:239], v[62:63] op_sel:[0,1] op_sel_hi:[1,1]
    v_cvt_pk_bf16_f32 v224, v224, v225
    v_cvt_pk_bf16_f32 v225, v226, v227
    ds_write_b64 v15, v[224:225] offset:12288
    v_cvt_pk_bf16_f32 v228, v228, v229
    v_cvt_pk_bf16_f32 v229, v230, v231
    ds_write_b64 v16, v[228:229] offset:12288
    v_cvt_pk_bf16_f32 v232, v232, v233
    v_cvt_pk_bf16_f32 v233, v234, v235
    ds_write_b64 v17, v[232:233] offset:12288
    v_cvt_pk_bf16_f32 v236, v236, v237
    v_cvt_pk_bf16_f32 v237, v238, v239
    ds_write_b64 v18, v[236:237] offset:12288
    v_pk_mul_f32 v[240:241], v[240:241], v[62:63] op_sel:[0,1] op_sel_hi:[1,1]
    v_pk_mul_f32 v[242:243], v[242:243], v[62:63] op_sel:[0,1] op_sel_hi:[1,1]
    v_pk_mul_f32 v[244:245], v[244:245], v[62:63] op_sel:[0,1] op_sel_hi:[1,1]
    v_pk_mul_f32 v[246:247], v[246:247], v[62:63] op_sel:[0,1] op_sel_hi:[1,1]
    v_pk_mul_f32 v[248:249], v[248:249], v[62:63] op_sel:[0,1] op_sel_hi:[1,1]
    v_pk_mul_f32 v[250:251], v[250:251], v[62:63] op_sel:[0,1] op_sel_hi:[1,1]
    v_pk_mul_f32 v[252:253], v[252:253], v[62:63] op_sel:[0,1] op_sel_hi:[1,1]
    v_pk_mul_f32 v[254:255], v[254:255], v[62:63] op_sel:[0,1] op_sel_hi:[1,1]
    v_cvt_pk_bf16_f32 v240, v240, v241
    v_cvt_pk_bf16_f32 v241, v242, v243
    ds_write_b64 v15, v[240:241] offset:12416
    v_cvt_pk_bf16_f32 v244, v244, v245
    v_cvt_pk_bf16_f32 v245, v246, v247
    ds_write_b64 v16, v[244:245] offset:12416
    v_cvt_pk_bf16_f32 v248, v248, v249
    v_cvt_pk_bf16_f32 v249, v250, v251
    ds_write_b64 v17, v[248:249] offset:12416
    v_cvt_pk_bf16_f32 v252, v252, v253
    v_cvt_pk_bf16_f32 v253, v254, v255
    ds_write_b64 v18, v[252:253] offset:12416
    ds_read_b128 a[64:67], v19 offset:12288
    ds_read_b128 a[68:71], v20 offset:13312
    ds_read_b128 a[72:75], v19 offset:14336
    ds_read_b128 a[76:79], v20 offset:15360
    s_waitcnt lgkmcnt(3)
    buffer_store_dwordx4 a[64:67], v21, s[20:23], s31 offen offset:0 nt
    s_waitcnt lgkmcnt(2)
    buffer_store_dwordx4 a[68:71], v21, s[20:23], s31 offen offset:1024 nt
    s_waitcnt lgkmcnt(1)
    buffer_store_dwordx4 a[72:75], v21, s[20:23], s31 offen offset:2048 nt
    s_waitcnt lgkmcnt(0)
    buffer_store_dwordx4 a[76:79], v21, s[20:23], s31 offen offset:3072 nt
    s_cmp_eq_u32 s41, 0
    s_cbranch_scc1 L_exit
    s_waitcnt vmcnt(0) lgkmcnt(0)
    s_add_u32 s54, s87, 0
    s_mul_i32 s55, s54, 171
    s_lshr_b32 s55, s55, 9
    s_mul_i32 s50, s55, 3
    s_sub_u32 s54, s54, s50
    s_add_u32 s55, s55, s86
    s_lshl_b32 s42, s55, 17
    s_mul_i32 s46, s55, 188416
    s_lshl_b32 s54, s54, 16
    s_add_u32 s46, s46, s54
    s_sub_u32 s50, 188416, s54
    s_min_u32 s50, s50, 0x10000
    s_add_u32 s54, s87, 32
    s_mul_i32 s55, s54, 171
    s_lshr_b32 s55, s55, 9
    s_mul_i32 s51, s55, 3
    s_sub_u32 s54, s54, s51
    s_add_u32 s55, s55, s86
    s_lshl_b32 s43, s55, 17
    s_mul_i32 s47, s55, 188416
    s_lshl_b32 s54, s54, 16
    s_add_u32 s47, s47, s54
    s_sub_u32 s51, 188416, s54
    s_min_u32 s51, s51, 0x10000
    s_add_u32 s54, s87, 64
    s_mul_i32 s55, s54, 171
    s_lshr_b32 s55, s55, 9
    s_mul_i32 s52, s55, 3
    s_sub_u32 s54, s54, s52
    s_add_u32 s55, s55, s86
    s_lshl_b32 s44, s55, 17
    s_mul_i32 s48, s55, 188416
    s_lshl_b32 s54, s54, 16
    s_add_u32 s48, s48, s54
    s_sub_u32 s52, 188416, s54
    s_min_u32 s52, s52, 0x10000
    v_bfe_u32 v28, v1, 2, 2
    v_lshlrev_b32 v28, 8, v28
    v_lshrrev_b32 v29, 4, v1
    v_lshl_or_b32 v28, v29, 6, v28
    v_and_b32 v29, 3, v1
    v_lshl_or_b32 v2, v29, 4, v28
    v_xor_b32 v3, 16, v2
    v_xor_b32 v4, 32, v2
    v_xor_b32 v5, 48, v2
    v_lshrrev_b32 v31, 5, v1
    v_bfe_u32 v28, v1, 2, 3
    v_and_b32 v29, 3, v28
    v_xor_b32 v29, v29, v31
    v_lshlrev_b32 v29, 4, v29
    v_lshl_or_b32 v29, v28, 10, v29
    v_and_b32 v30, 3, v1
    v_lshl_or_b32 v7, v30, 6, v29
    v_xor_b32 v8, 32, v7
    v_add_u32 v13, s34, v7
    v_add_u32 v14, s34, v8
    v_bfe_u32 v28, v1, 2, 2
    v_lshlrev_b32 v28, 6, v28
    v_lshl_or_b32 v28, v31, 10, v28
    v_and_b32 v29, 1, v1
    v_lshl_or_b32 v28, v29, 5, v28
    v_and_b32 v29, 16, v1
    v_or_b32 v28, v28, v29
    v_bfe_u32 v29, v1, 1, 1
    v_lshl_or_b32 v28, v29, 3, v28
    v_add_u32 v9, 49152, v28
    v_and_b32 v28, 7, v1
    v_lshlrev_b32 v29, 1, v31
    v_xor_b32 v28, v28, v29
    v_lshlrev_b32 v28, 4, v28
    v_and_b32 v29, 31, v1
    v_lshl_or_b32 v28, v29, 8, v28
    v_add_u32 v15, s34, v28
    v_xor_b32 v16, 16, v15
    v_xor_b32 v17, 64, v15
    v_xor_b32 v18, 80, v15
    v_lshrrev_b32 v28, 4, v1
    v_and_b32 v29, 15, v1
    v_xor_b32 v29, v29, v28
    v_lshlrev_b32 v29, 4, v29
    v_lshl_or_b32 v29, v28, 8, v29
    v_add_u32 v19, s34, v29
    v_xor_b32 v20, 64, v19
    v_lshlrev_b32 v21, 4, v1
    s_mov_b32 s40, 0
L_fb:
    s_and_b32 s54, s41, 4
    s_cbranch_scc0 L_fbn
    s_add_u32 s16, s4, s46
    s_addc_u32 s17, s5, 0
    s_mov_b32 s18, s50
    s_add_u32 s20, s6, s46
    s_addc_u32 s21, s7, 0
    s_mov_b32 s22, s50
    s_mov_b32 s56, s42
    s_waitcnt vmcnt(0) lgkmcnt(0)
    s_mov_b32 m0, s58
    s_nop 0
    buffer_load_dwordx4 v2, s[16:19], s28 offen offset:0 lds
    buffer_load_dwordx4 v3, s[16:19], s28 offen offset:1024 lds
    buffer_load_dwordx4 v4, s[16:19], s28 offen offset:2048 lds
    buffer_load_dwordx4 v5, s[16:19], s28 offen offset:3072 lds
    s_mov_b32 m0, s59
    s_nop 0
    buffer_load_dwordx4 v2, s[16:19], s29 offen offset:0 lds
    buffer_load_dwordx4 v3, s[16:19], s29 offen offset:1024 lds
    buffer_load_dwordx4 v4, s[16:19], s29 offen offset:2048 lds
    buffer_load_dwordx4 v5, s[16:19], s29 offen offset:3072 lds
    s_mov_b32 m0, s60
    s_nop 0
    buffer_load_dwordx4 v2, s[16:19], s30 offen offset:0 lds
    buffer_load_dwordx4 v3, s[16:19], s30 offen offset:1024 lds
    buffer_load_dwordx4 v4, s[16:19], s30 offen offset:2048 lds
    buffer_load_dwordx4 v5, s[16:19], s30 offen offset:3072 lds
    s_mov_b32 m0, s61
    s_nop 0
    buffer_load_dwordx4 v2, s[16:19], s31 offen offset:0 lds
    buffer_load_dwordx4 v3, s[16:19], s31 offen offset:1024 lds
    buffer_load_dwordx4 v4, s[16:19], s31 offen offset:2048 lds
    buffer_load_dwordx4 v5, s[16:19], s31 offen offset:3072 lds
    v_subrev_u32 v37, 40960, v9
    v_add_u32 v37, s34, v37
    v_mov_b32 v128, 0
    v_mov_b32 v129, 0
    v_mov_b32 v130, 0
    v_mov_b32 v131, 0
    v_mov_b32 v132, 0
    v_mov_b32 v133, 0
    v_mov_b32 v134, 0
    v_mov_b32 v135, 0
    v_mov_b32 v136, 0
    v_mov_b32 v137, 0
    v_mov_b32 v138, 0
    v_mov_b32 v139, 0
    v_mov_b32 v140, 0
    v_mov_b32 v141, 0
    v_mov_b32 v142, 0
    v_mov_b32 v143, 0
    v_mov_b32 v144, 0
    v_mov_b32 v145, 0
    v_mov_b32 v146, 0
    v_mov_b32 v147, 0
    v_mov_b32 v148, 0
    v_mov_b32 v149, 0
    v_mov_b32 v150, 0
    v_mov_b32 v151, 0
    v_mov_b32 v152, 0
    v_mov_b32 v153, 0
    v_mov_b32 v154, 0
    v_mov_b32 v155, 0
    v_mov_b32 v156, 0
    v_mov_b32 v157, 0
    v_mov_b32 v158, 0
    v_mov_b32 v159, 0
    v_mov_b32 v160, 0
    v_mov_b32 v161, 0
    v_mov_b32 v162, 0
    v_mov_b32 v163, 0
    v_mov_b32 v164, 0
    v_mov_b32 v165, 0
    v_mov_b32 v166, 0
    v_mov_b32 v167, 0
    v_mov_b32 v168, 0
    v_mov_b32 v169, 0
    v_mov_b32 v170, 0
    v_mov_b32 v171, 0
    v_mov_b32 v172, 0
    v_mov_b32 v173, 0
    v_mov_b32 v174, 0
    v_mov_b32 v175, 0
    v_mov_b32 v176, 0
    v_mov_b32 v177, 0
    v_mov_b32 v178, 0
    v_mov_b32 v179, 0
    v_mov_b32 v180, 0
    v_mov_b32 v181, 0
    v_mov_b32 v182, 0
    v_mov_b32 v183, 0
    v_mov_b32 v184, 0
    v_mov_b32 v185, 0
    v_mov_b32 v186, 0
    v_mov_b32 v187, 0
    v_mov_b32 v188, 0
    v_mov_b32 v189, 0
    v_mov_b32 v190, 0
    v_mov_b32 v191, 0
    v_mov_b32 v192, 0
    v_mov_b32 v193, 0
    v_mov_b32 v194, 0
    v_mov_b32 v195, 0
    v_mov_b32 v196, 0
    v_mov_b32 v197, 0
    v_mov_b32 v198, 0
    v_mov_b32 v199, 0
    v_mov_b32 v200, 0
    v_mov_b32 v201, 0
    v_mov_b32 v202, 0
    v_mov_b32 v203, 0
    v_mov_b32 v204, 0
    v_mov_b32 v205, 0
    v_mov_b32 v206, 0
    v_mov_b32 v207, 0
    v_mov_b32 v208, 0
    v_mov_b32 v209, 0
    v_mov_b32 v210, 0
    v_mov_b32 v211, 0
    v_mov_b32 v212, 0
    v_mov_b32 v213, 0
    v_mov_b32 v214, 0
    v_mov_b32 v215, 0
    v_mov_b32 v216, 0
    v_mov_b32 v217, 0
    v_mov_b32 v218, 0
    v_mov_b32 v219, 0
    v_mov_b32 v220, 0
    v_mov_b32 v221, 0
    v_mov_b32 v222, 0
    v_mov_b32 v223, 0
    v_mov_b32 v224, 0
    v_mov_b32 v225, 0
    v_mov_b32 v226, 0
    v_mov_b32 v227, 0
    v_mov_b32 v228, 0
    v_mov_b32 v229, 0
    v_mov_b32 v230, 0
    v_mov_b32 v231, 0
    v_mov_b32 v232, 0
    v_mov_b32 v233, 0
    v_mov_b32 v234, 0
    v_mov_b32 v235, 0
    v_mov_b32 v236, 0
    v_mov_b32 v237, 0
    v_mov_b32 v238, 0
    v_mov_b32 v239, 0
    v_mov_b32 v240, 0
    v_mov_b32 v241, 0
    v_mov_b32 v242, 0
    v_mov_b32 v243, 0
    v_mov_b32 v244, 0
    v_mov_b32 v245, 0
    v_mov_b32 v246, 0
    v_mov_b32 v247, 0
    v_mov_b32 v248, 0
    v_mov_b32 v249, 0
    v_mov_b32 v250, 0
    v_mov_b32 v251, 0
    v_mov_b32 v252, 0
    v_mov_b32 v253, 0
    v_mov_b32 v254, 0
    v_mov_b32 v255, 0
    v_mov_b32 v32, 0xff800000
    v_mov_b32 v24, 0
    v_mov_b32 v33, 0xff800000
    v_mov_b32 v25, 0
    s_waitcnt vmcnt(0)
    ds_read_b128 a[0:3], v13 offset:0
    ds_read_b128 a[4:7], v14 offset:0
    ds_read_b128 a[8:11], v13 offset:256
    ds_read_b128 a[12:15], v14 offset:256
    ds_read_b128 a[16:19], v13 offset:512
    ds_read_b128 a[20:23], v14 offset:512
    ds_read_b128 a[24:27], v13 offset:768
    ds_read_b128 a[28:31], v14 offset:768
    ds_read_b128 a[32:35], v13 offset:8192
    ds_read_b128 a[36:39], v14 offset:8192
    ds_read_b128 a[40:43], v13 offset:8448
    ds_read_b128 a[44:47], v14 offset:8448
    ds_read_b128 a[48:51], v13 offset:8704
    ds_read_b128 a[52:55], v14 offset:8704
    ds_read_b128 a[56:59], v13 offset:8960
    ds_read_b128 a[60:63], v14 offset:8960
    s_mov_b32 s57, 16
L_sl:
    s_waitcnt lgkmcnt(0)
    s_add_u32 s55, s56, 4096
    s_mov_b32 m0, s58
    s_nop 0
    buffer_load_dwordx4 v2, s[8:11], s56 offen offset:0 lds
    buffer_load_dwordx4 v3, s[8:11], s56 offen offset:1024 lds
    buffer_load_dwordx4 v4, s[8:11], s56 offen offset:2048 lds
    buffer_load_dwordx4 v5, s[8:11], s56 offen offset:3072 lds
    s_mov_b32 m0, s59
    s_nop 0
    buffer_load_dwordx4 v2, s[8:11], s55 offen offset:0 lds
    buffer_load_dwordx4 v3, s[8:11], s55 offen offset:1024 lds
    buffer_load_dwordx4 v4, s[8:11], s55 offen offset:2048 lds
    buffer_load_dwordx4 v5, s[8:11], s55 offen offset:3072 lds
    s_mov_b32 m0, s60
    s_nop 0
    buffer_load_dwordx4 v2, s[12:15], s56 offen offset:0 lds
    buffer_load_dwordx4 v2, s[12:15], s56 offen offset:1024 lds
    buffer_load_dwordx4 v2, s[12:15], s56 offen offset:2048 lds
    buffer_load_dwordx4 v2, s[12:15], s56 offen offset:3072 lds
    s_mov_b32 m0, s61
    s_nop 0
    buffer_load_dwordx4 v2, s[12:15], s55 offen offset:0 lds
    buffer_load_dwordx4 v2, s[12:15], s55 offen offset:1024 lds
    buffer_load_dwordx4 v2, s[12:15], s55 offen offset:2048 lds
    buffer_load_dwordx4 v2, s[12:15], s55 offen offset:3072 lds
    s_add_u32 s56, s56, 8192
    s_waitcnt vmcnt(0)
    ds_read_b128 a[64:67], v13 offset:0
    ds_read_b128 a[68:71], v14 offset:0
    ds_read_b128 a[72:75], v13 offset:256
    ds_read_b128 a[76:79], v14 offset:256
    ds_read_b128 a[80:83], v13 offset:512
    ds_read_b128 a[84:87], v14 offset:512
    ds_read_b128 a[88:91], v13 offset:768
    ds_read_b128 a[92:95], v14 offset:768
    ds_read_b64_tr_b16 a[96:97], v37 offset:0
    ds_read_b64_tr_b16 a[98:99], v37 offset:2048
    ds_read_b64_tr_b16 a[100:101], v37 offset:256
    ds_read_b64_tr_b16 a[102:103], v37 offset:2304
    ds_read_b64_tr_b16 a[104:105], v37 offset:512
    ds_read_b64_tr_b16 a[106:107], v37 offset:2560
    ds_read_b64_tr_b16 a[108:109], v37 offset:768
    ds_read_b64_tr_b16 a[110:111], v37 offset:2816
    ds_read_b64_tr_b16 a[112:113], v37 offset:4096
    ds_read_b64_tr_b16 a[114:115], v37 offset:6144
    ds_read_b64_tr_b16 a[116:117], v37 offset:4352
    ds_read_b64_tr_b16 a[118:119], v37 offset:6400
    ds_read_b64_tr_b16 a[120:121], v37 offset:4608
    ds_read_b64_tr_b16 a[122:123], v37 offset:6656
    ds_read_b64_tr_b16 a[124:125], v37 offset:4864
    ds_read_b64_tr_b16 a[126:127], v37 offset:6912
    s_waitcnt lgkmcnt(15)
    v_mfma_f32_32x32x16_bf16 v[64:79], a[64:67], a[0:3], 0
    v_mfma_f32_32x32x16_bf16 v[64:79], a[68:71], a[4:7], v[64:79]
    v_mfma_f32_32x32x16_bf16 v[64:79], a[72:75], a[8:11], v[64:79]
    v_mfma_f32_32x32x16_bf16 v[64:79], a[76:79], a[12:15], v[64:79]
    v_mfma_f32_32x32x16_bf16 v[64:79], a[80:83], a[16:19], v[64:79]
    v_mfma_f32_32x32x16_bf16 v[64:79], a[84:87], a[20:23], v[64:79]
    v_mfma_f32_32x32x16_bf16 v[64:79], a[88:91], a[24:27], v[64:79]
    v_mfma_f32_32x32x16_bf16 v[64:79], a[92:95], a[28:31], v[64:79]
    v_mfma_f32_32x32x16_bf16 v[80:95], a[64:67], a[32:35], 0
    v_mfma_f32_32x32x16_bf16 v[80:95], a[68:71], a[36:39], v[80:95]
    v_mfma_f32_32x32x16_bf16 v[80:95], a[72:75], a[40:43], v[80:95]
    v_mfma_f32_32x32x16_bf16 v[80:95], a[76:79], a[44:47], v[80:95]
    v_mfma_f32_32x32x16_bf16 v[80:95], a[80:83], a[48:51], v[80:95]
    v_mfma_f32_32x32x16_bf16 v[80:95], a[84:87], a[52:55], v[80:95]
    v_mfma_f32_32x32x16_bf16 v[80:95], a[88:91], a[56:59], v[80:95]
    v_mfma_f32_32x32x16_bf16 v[80:95], a[92:95], a[60:63], v[80:95]
    v_max3_f32 v35, v64, v65, v66
    v_max3_f32 v36, v67, v68, v69
    v_max3_f32 v35, v35, v70, v71
    v_max3_f32 v36, v36, v72, v73
    v_max3_f32 v35, v35, v74, v75
    v_max3_f32 v36, v36, v76, v77
    v_max3_f32 v35, v35, v78, v79
    v_max_f32 v35, v35, v36
    v_mov_b32 v36, v35
    s_nop 1
    v_permlane32_swap_b32 v35, v36
    v_max_f32 v35, v35, v36
    v_max_f32 v35, v35, v32
    v_sub_f32 v36, v32, v35
    v_mul_f32 v36, s24, v36
    v_exp_f32 v34, v36
    v_mov_b32 v32, v35
    v_mul_f32 v22, s24, v35
    v_mul_f32 v24, v24, v34
    v_mul_f32 v128, v128, v34
    v_mul_f32 v129, v129, v34
    v_mul_f32 v130, v130, v34
    v_mul_f32 v131, v131, v34
    v_mul_f32 v132, v132, v34
    v_mul_f32 v133, v133, v34
    v_mul_f32 v134, v134, v34
    v_mul_f32 v135, v135, v34
    v_mul_f32 v136, v136, v34
    v_mul_f32 v137, v137, v34
    v_mul_f32 v138, v138, v34
    v_mul_f32 v139, v139, v34
    v_mul_f32 v140, v140, v34
    v_mul_f32 v141, v141, v34
    v_mul_f32 v142, v142, v34
    v_mul_f32 v143, v143, v34
    v_mul_f32 v144, v144, v34
    v_mul_f32 v145, v145, v34
    v_mul_f32 v146, v146, v34
    v_mul_f32 v147, v147, v34
    v_mul_f32 v148, v148, v34
    v_mul_f32 v149, v149, v34
    v_mul_f32 v150, v150, v34
    v_mul_f32 v151, v151, v34
    v_mul_f32 v152, v152, v34
    v_mul_f32 v153, v153, v34
    v_mul_f32 v154, v154, v34
    v_mul_f32 v155, v155, v34
    v_mul_f32 v156, v156, v34
    v_mul_f32 v157, v157, v34
    v_mul_f32 v158, v158, v34
    v_mul_f32 v159, v159, v34
    v_mul_f32 v160, v160, v34
    v_mul_f32 v161, v161, v34
    v_mul_f32 v162, v162, v34
    v_mul_f32 v163, v163, v34
    v_mul_f32 v164, v164, v34
    v_mul_f32 v165, v165, v34
    v_mul_f32 v166, v166, v34
    v_mul_f32 v167, v167, v34
    v_mul_f32 v168, v168, v34
    v_mul_f32 v169, v169, v34
    v_mul_f32 v170, v170, v34
    v_mul_f32 v171, v171, v34
    v_mul_f32 v172, v172, v34
    v_mul_f32 v173, v173, v34
    v_mul_f32 v174, v174, v34
    v_mul_f32 v175, v175, v34
    v_mul_f32 v176, v176, v34
    v_mul_f32 v177, v177, v34
    v_mul_f32 v178, v178, v34
    v_mul_f32 v179, v179, v34
    v_mul_f32 v180, v180, v34
    v_mul_f32 v181, v181, v34
    v_mul_f32 v182, v182, v34
    v_mul_f32 v183, v183, v34
    v_mul_f32 v184, v184, v34
    v_mul_f32 v185, v185, v34
    v_mul_f32 v186, v186, v34
    v_mul_f32 v187, v187, v34
    v_mul_f32 v188, v188, v34
    v_mul_f32 v189, v189, v34
    v_mul_f32 v190, v190, v34
    v_mul_f32 v191, v191, v34
    v_fma_f32 v64, v64, s24, -v22
    v_fma_f32 v65, v65, s24, -v22
    v_fma_f32 v66, v66, s24, -v22
    v_fma_f32 v67, v67, s24, -v22
    v_fma_f32 v68, v68, s24, -v22
    v_fma_f32 v69, v69, s24, -v22
    v_fma_f32 v70, v70, s24, -v22
    v_fma_f32 v71, v71, s24, -v22
    v_fma_f32 v72, v72, s24, -v22
    v_fma_f32 v73, v73, s24, -v22
    v_fma_f32 v74, v74, s24, -v22
    v_fma_f32 v75, v75, s24, -v22
    v_fma_f32 v76, v76, s24, -v22
    v_fma_f32 v77, v77, s24, -v22
    v_fma_f32 v78, v78, s24, -v22
    v_fma_f32 v79, v79, s24, -v22
    v_exp_f32 v64, v64
    v_exp_f32 v65, v65
    v_exp_f32 v66, v66
    v_exp_f32 v67, v67
    v_exp_f32 v68, v68
    v_exp_f32 v69, v69
    v_exp_f32 v70, v70
    v_exp_f32 v71, v71
    v_exp_f32 v72, v72
    v_exp_f32 v73, v73
    v_exp_f32 v74, v74
    v_exp_f32 v75, v75
    v_exp_f32 v76, v76
    v_exp_f32 v77, v77
    v_exp_f32 v78, v78
    v_exp_f32 v79, v79
    v_add_f32 v24, v24, v64
    v_add_f32 v24, v24, v65
    v_add_f32 v24, v24, v66
    v_add_f32 v24, v24, v67
    v_add_f32 v24, v24, v68
    v_add_f32 v24, v24, v69
    v_add_f32 v24, v24, v70
    v_add_f32 v24, v24, v71
    v_add_f32 v24, v24, v72
    v_add_f32 v24, v24, v73
    v_add_f32 v24, v24, v74
    v_add_f32 v24, v24, v75
    v_add_f32 v24, v24, v76
    v_add_f32 v24, v24, v77
    v_add_f32 v24, v24, v78
    v_add_f32 v24, v24, v79
    v_cvt_pk_bf16_f32 v64, v64, v65
    v_cvt_pk_bf16_f32 v65, v66, v67
    v_cvt_pk_bf16_f32 v66, v68, v69
    v_cvt_pk_bf16_f32 v67, v70, v71
    v_cvt_pk_bf16_f32 v72, v72, v73
    v_cvt_pk_bf16_f32 v73, v74, v75
    v_cvt_pk_bf16_f32 v74, v76, v77
    v_cvt_pk_bf16_f32 v75, v78, v79
    v_max3_f32 v35, v80, v81, v82
    v_max3_f32 v36, v83, v84, v85
    v_max3_f32 v35, v35, v86, v87
    v_max3_f32 v36, v36, v88, v89
    v_max3_f32 v35, v35, v90, v91
    v_max3_f32 v36, v36, v92, v93
    v_max3_f32 v35, v35, v94, v95
    v_max_f32 v35, v35, v36
    v_mov_b32 v36, v35
    s_nop 1
    v_permlane32_swap_b32 v35, v36
    v_max_f32 v35, v35, v36
    v_max_f32 v35, v35, v33
    v_sub_f32 v36, v33, v35
    v_mul_f32 v36, s24, v36
    v_exp_f32 v34, v36
    v_mov_b32 v33, v35
    v_mul_f32 v23, s24, v35
    v_mul_f32 v25, v25, v34
    v_mul_f32 v192, v192, v34
    v_mul_f32 v193, v193, v34
    v_mul_f32 v194, v194, v34
    v_mul_f32 v195, v195, v34
    v_mul_f32 v196, v196, v34
    v_mul_f32 v197, v197, v34
    v_mul_f32 v198, v198, v34
    v_mul_f32 v199, v199, v34
    v_mul_f32 v200, v200, v34
    v_mul_f32 v201, v201, v34
    v_mul_f32 v202, v202, v34
    v_mul_f32 v203, v203, v34
    v_mul_f32 v204, v204, v34
    v_mul_f32 v205, v205, v34
    v_mul_f32 v206, v206, v34
    v_mul_f32 v207, v207, v34
    v_mul_f32 v208, v208, v34
    v_mul_f32 v209, v209, v34
    v_mul_f32 v210, v210, v34
    v_mul_f32 v211, v211, v34
    v_mul_f32 v212, v212, v34
    v_mul_f32 v213, v213, v34
    v_mul_f32 v214, v214, v34
    v_mul_f32 v215, v215, v34
    v_mul_f32 v216, v216, v34
    v_mul_f32 v217, v217, v34
    v_mul_f32 v218, v218, v34
    v_mul_f32 v219, v219, v34
    v_mul_f32 v220, v220, v34
    v_mul_f32 v221, v221, v34
    v_mul_f32 v222, v222, v34
    v_mul_f32 v223, v223, v34
    v_mul_f32 v224, v224, v34
    v_mul_f32 v225, v225, v34
    v_mul_f32 v226, v226, v34
    v_mul_f32 v227, v227, v34
    v_mul_f32 v228, v228, v34
    v_mul_f32 v229, v229, v34
    v_mul_f32 v230, v230, v34
    v_mul_f32 v231, v231, v34
    v_mul_f32 v232, v232, v34
    v_mul_f32 v233, v233, v34
    v_mul_f32 v234, v234, v34
    v_mul_f32 v235, v235, v34
    v_mul_f32 v236, v236, v34
    v_mul_f32 v237, v237, v34
    v_mul_f32 v238, v238, v34
    v_mul_f32 v239, v239, v34
    v_mul_f32 v240, v240, v34
    v_mul_f32 v241, v241, v34
    v_mul_f32 v242, v242, v34
    v_mul_f32 v243, v243, v34
    v_mul_f32 v244, v244, v34
    v_mul_f32 v245, v245, v34
    v_mul_f32 v246, v246, v34
    v_mul_f32 v247, v247, v34
    v_mul_f32 v248, v248, v34
    v_mul_f32 v249, v249, v34
    v_mul_f32 v250, v250, v34
    v_mul_f32 v251, v251, v34
    v_mul_f32 v252, v252, v34
    v_mul_f32 v253, v253, v34
    v_mul_f32 v254, v254, v34
    v_mul_f32 v255, v255, v34
    v_fma_f32 v80, v80, s24, -v23
    v_fma_f32 v81, v81, s24, -v23
    v_fma_f32 v82, v82, s24, -v23
    v_fma_f32 v83, v83, s24, -v23
    v_fma_f32 v84, v84, s24, -v23
    v_fma_f32 v85, v85, s24, -v23
    v_fma_f32 v86, v86, s24, -v23
    v_fma_f32 v87, v87, s24, -v23
    v_fma_f32 v88, v88, s24, -v23
    v_fma_f32 v89, v89, s24, -v23
    v_fma_f32 v90, v90, s24, -v23
    v_fma_f32 v91, v91, s24, -v23
    v_fma_f32 v92, v92, s24, -v23
    v_fma_f32 v93, v93, s24, -v23
    v_fma_f32 v94, v94, s24, -v23
    v_fma_f32 v95, v95, s24, -v23
    v_exp_f32 v80, v80
    v_exp_f32 v81, v81
    v_exp_f32 v82, v82
    v_exp_f32 v83, v83
    v_exp_f32 v84, v84
    v_exp_f32 v85, v85
    v_exp_f32 v86, v86
    v_exp_f32 v87, v87
    v_exp_f32 v88, v88
    v_exp_f32 v89, v89
    v_exp_f32 v90, v90
    v_exp_f32 v91, v91
    v_exp_f32 v92, v92
    v_exp_f32 v93, v93
    v_exp_f32 v94, v94
    v_exp_f32 v95, v95
    v_add_f32 v25, v25, v80
    v_add_f32 v25, v25, v81
    v_add_f32 v25, v25, v82
    v_add_f32 v25, v25, v83
    v_add_f32 v25, v25, v84
    v_add_f32 v25, v25, v85
    v_add_f32 v25, v25, v86
    v_add_f32 v25, v25, v87
    v_add_f32 v25, v25, v88
    v_add_f32 v25, v25, v89
    v_add_f32 v25, v25, v90
    v_add_f32 v25, v25, v91
    v_add_f32 v25, v25, v92
    v_add_f32 v25, v25, v93
    v_add_f32 v25, v25, v94
    v_add_f32 v25, v25, v95
    v_cvt_pk_bf16_f32 v80, v80, v81
    v_cvt_pk_bf16_f32 v81, v82, v83
    v_cvt_pk_bf16_f32 v82, v84, v85
    v_cvt_pk_bf16_f32 v83, v86, v87
    v_cvt_pk_bf16_f32 v88, v88, v89
    v_cvt_pk_bf16_f32 v89, v90, v91
    v_cvt_pk_bf16_f32 v90, v92, v93
    v_cvt_pk_bf16_f32 v91, v94, v95
    s_waitcnt lgkmcnt(14)
    v_mfma_f32_32x32x16_bf16 v[128:143], a[96:99], v[64:67], v[128:143]
    s_waitcnt lgkmcnt(6)
    v_mfma_f32_32x32x16_bf16 v[128:143], a[112:115], v[72:75], v[128:143]
    v_mfma_f32_32x32x16_bf16 v[144:159], a[100:103], v[64:67], v[144:159]
    s_waitcnt lgkmcnt(4)
    v_mfma_f32_32x32x16_bf16 v[144:159], a[116:119], v[72:75], v[144:159]
    v_mfma_f32_32x32x16_bf16 v[160:175], a[104:107], v[64:67], v[160:175]
    s_waitcnt lgkmcnt(2)
    v_mfma_f32_32x32x16_bf16 v[160:175], a[120:123], v[72:75], v[160:175]
    v_mfma_f32_32x32x16_bf16 v[176:191], a[108:111], v[64:67], v[176:191]
    s_waitcnt lgkmcnt(0)
    v_mfma_f32_32x32x16_bf16 v[176:191], a[124:127], v[72:75], v[176:191]
    v_mfma_f32_32x32x16_bf16 v[192:207], a[96:99], v[80:83], v[192:207]
    v_mfma_f32_32x32x16_bf16 v[192:207], a[112:115], v[88:91], v[192:207]
    v_mfma_f32_32x32x16_bf16 v[208:223], a[100:103], v[80:83], v[208:223]
    v_mfma_f32_32x32x16_bf16 v[208:223], a[116:119], v[88:91], v[208:223]
    v_mfma_f32_32x32x16_bf16 v[224:239], a[104:107], v[80:83], v[224:239]
    v_mfma_f32_32x32x16_bf16 v[224:239], a[120:123], v[88:91], v[224:239]
    v_mfma_f32_32x32x16_bf16 v[240:255], a[108:111], v[80:83], v[240:255]
    v_mfma_f32_32x32x16_bf16 v[240:255], a[124:127], v[88:91], v[240:255]
    s_sub_u32 s57, s57, 1
    s_cmp_lg_u32 s57, 0
    s_cbranch_scc1 L_sl
    v_mov_b32 v35, v24
    s_nop 1
    v_permlane32_swap_b32 v24, v35
    v_add_f32 v35, v24, v35
    v_rcp_f32 v26, v35
    s_nop 0
    v_mul_f32 v128, v128, v26
    v_mul_f32 v129, v129, v26
    v_mul_f32 v130, v130, v26
    v_mul_f32 v131, v131, v26
    v_mul_f32 v132, v132, v26
    v_mul_f32 v133, v133, v26
    v_mul_f32 v134, v134, v26
    v_mul_f32 v135, v135, v26
    v_mul_f32 v136, v136, v26
    v_mul_f32 v137, v137, v26
    v_mul_f32 v138, v138, v26
    v_mul_f32 v139, v139, v26
    v_mul_f32 v140, v140, v26
    v_mul_f32 v141, v141, v26
    v_mul_f32 v142, v142, v26
    v_mul_f32 v143, v143, v26
    v_cvt_pk_bf16_f32 v128, v128, v129
    v_cvt_pk_bf16_f32 v129, v130, v131
    v_cvt_pk_bf16_f32 v130, v132, v133
    v_cvt_pk_bf16_f32 v131, v134, v135
    v_cvt_pk_bf16_f32 v132, v136, v137
    v_cvt_pk_bf16_f32 v133, v138, v139
    v_cvt_pk_bf16_f32 v134, v140, v141
    v_cvt_pk_bf16_f32 v135, v142, v143
    ds_write_b128 v15, v[128:131] offset:0
    ds_write_b128 v16, v[132:135] offset:0
    v_mul_f32 v144, v144, v26
    v_mul_f32 v145, v145, v26
    v_mul_f32 v146, v146, v26
    v_mul_f32 v147, v147, v26
    v_mul_f32 v148, v148, v26
    v_mul_f32 v149, v149, v26
    v_mul_f32 v150, v150, v26
    v_mul_f32 v151, v151, v26
    v_mul_f32 v152, v152, v26
    v_mul_f32 v153, v153, v26
    v_mul_f32 v154, v154, v26
    v_mul_f32 v155, v155, v26
    v_mul_f32 v156, v156, v26
    v_mul_f32 v157, v157, v26
    v_mul_f32 v158, v158, v26
    v_mul_f32 v159, v159, v26
    v_cvt_pk_bf16_f32 v144, v144, v145
    v_cvt_pk_bf16_f32 v145, v146, v147
    v_cvt_pk_bf16_f32 v146, v148, v149
    v_cvt_pk_bf16_f32 v147, v150, v151
    v_cvt_pk_bf16_f32 v148, v152, v153
    v_cvt_pk_bf16_f32 v149, v154, v155
    v_cvt_pk_bf16_f32 v150, v156, v157
    v_cvt_pk_bf16_f32 v151, v158, v159
    ds_write_b128 v17, v[144:147] offset:0
    ds_write_b128 v18, v[148:151] offset:0
    v_mul_f32 v160, v160, v26
    v_mul_f32 v161, v161, v26
    v_mul_f32 v162, v162, v26
    v_mul_f32 v163, v163, v26
    v_mul_f32 v164, v164, v26
    v_mul_f32 v165, v165, v26
    v_mul_f32 v166, v166, v26
    v_mul_f32 v167, v167, v26
    v_mul_f32 v168, v168, v26
    v_mul_f32 v169, v169, v26
    v_mul_f32 v170, v170, v26
    v_mul_f32 v171, v171, v26
    v_mul_f32 v172, v172, v26
    v_mul_f32 v173, v173, v26
    v_mul_f32 v174, v174, v26
    v_mul_f32 v175, v175, v26
    v_cvt_pk_bf16_f32 v160, v160, v161
    v_cvt_pk_bf16_f32 v161, v162, v163
    v_cvt_pk_bf16_f32 v162, v164, v165
    v_cvt_pk_bf16_f32 v163, v166, v167
    v_cvt_pk_bf16_f32 v164, v168, v169
    v_cvt_pk_bf16_f32 v165, v170, v171
    v_cvt_pk_bf16_f32 v166, v172, v173
    v_cvt_pk_bf16_f32 v167, v174, v175
    ds_write_b128 v15, v[160:163] offset:128
    ds_write_b128 v16, v[164:167] offset:128
    v_mul_f32 v176, v176, v26
    v_mul_f32 v177, v177, v26
    v_mul_f32 v178, v178, v26
    v_mul_f32 v179, v179, v26
    v_mul_f32 v180, v180, v26
    v_mul_f32 v181, v181, v26
    v_mul_f32 v182, v182, v26
    v_mul_f32 v183, v183, v26
    v_mul_f32 v184, v184, v26
    v_mul_f32 v185, v185, v26
    v_mul_f32 v186, v186, v26
    v_mul_f32 v187, v187, v26
    v_mul_f32 v188, v188, v26
    v_mul_f32 v189, v189, v26
    v_mul_f32 v190, v190, v26
    v_mul_f32 v191, v191, v26
    v_cvt_pk_bf16_f32 v176, v176, v177
    v_cvt_pk_bf16_f32 v177, v178, v179
    v_cvt_pk_bf16_f32 v178, v180, v181
    v_cvt_pk_bf16_f32 v179, v182, v183
    v_cvt_pk_bf16_f32 v180, v184, v185
    v_cvt_pk_bf16_f32 v181, v186, v187
    v_cvt_pk_bf16_f32 v182, v188, v189
    v_cvt_pk_bf16_f32 v183, v190, v191
    ds_write_b128 v17, v[176:179] offset:128
    ds_write_b128 v18, v[180:183] offset:128
    v_mov_b32 v35, v25
    s_nop 1
    v_permlane32_swap_b32 v25, v35
    v_add_f32 v35, v25, v35
    v_rcp_f32 v27, v35
    s_nop 0
    v_mul_f32 v192, v192, v27
    v_mul_f32 v193, v193, v27
    v_mul_f32 v194, v194, v27
    v_mul_f32 v195, v195, v27
    v_mul_f32 v196, v196, v27
    v_mul_f32 v197, v197, v27
    v_mul_f32 v198, v198, v27
    v_mul_f32 v199, v199, v27
    v_mul_f32 v200, v200, v27
    v_mul_f32 v201, v201, v27
    v_mul_f32 v202, v202, v27
    v_mul_f32 v203, v203, v27
    v_mul_f32 v204, v204, v27
    v_mul_f32 v205, v205, v27
    v_mul_f32 v206, v206, v27
    v_mul_f32 v207, v207, v27
    v_cvt_pk_bf16_f32 v192, v192, v193
    v_cvt_pk_bf16_f32 v193, v194, v195
    v_cvt_pk_bf16_f32 v194, v196, v197
    v_cvt_pk_bf16_f32 v195, v198, v199
    v_cvt_pk_bf16_f32 v196, v200, v201
    v_cvt_pk_bf16_f32 v197, v202, v203
    v_cvt_pk_bf16_f32 v198, v204, v205
    v_cvt_pk_bf16_f32 v199, v206, v207
    ds_write_b128 v15, v[192:195] offset:8192
    ds_write_b128 v16, v[196:199] offset:8192
    v_mul_f32 v208, v208, v27
    v_mul_f32 v209, v209, v27
    v_mul_f32 v210, v210, v27
    v_mul_f32 v211, v211, v27
    v_mul_f32 v212, v212, v27
    v_mul_f32 v213, v213, v27
    v_mul_f32 v214, v214, v27
    v_mul_f32 v215, v215, v27
    v_mul_f32 v216, v216, v27
    v_mul_f32 v217, v217, v27
    v_mul_f32 v218, v218, v27
    v_mul_f32 v219, v219, v27
    v_mul_f32 v220, v220, v27
    v_mul_f32 v221, v221, v27
    v_mul_f32 v222, v222, v27
    v_mul_f32 v223, v223, v27
    v_cvt_pk_bf16_f32 v208, v208, v209
    v_cvt_pk_bf16_f32 v209, v210, v211
    v_cvt_pk_bf16_f32 v210, v212, v213
    v_cvt_pk_bf16_f32 v211, v214, v215
    v_cvt_pk_bf16_f32 v212, v216, v217
    v_cvt_pk_bf16_f32 v213, v218, v219
    v_cvt_pk_bf16_f32 v214, v220, v221
    v_cvt_pk_bf16_f32 v215, v222, v223
    ds_write_b128 v17, v[208:211] offset:8192
    ds_write_b128 v18, v[212:215] offset:8192
    v_mul_f32 v224, v224, v27
    v_mul_f32 v225, v225, v27
    v_mul_f32 v226, v226, v27
    v_mul_f32 v227, v227, v27
    v_mul_f32 v228, v228, v27
    v_mul_f32 v229, v229, v27
    v_mul_f32 v230, v230, v27
    v_mul_f32 v231, v231, v27
    v_mul_f32 v232, v232, v27
    v_mul_f32 v233, v233, v27
    v_mul_f32 v234, v234, v27
    v_mul_f32 v235, v235, v27
    v_mul_f32 v236, v236, v27
    v_mul_f32 v237, v237, v27
    v_mul_f32 v238, v238, v27
    v_mul_f32 v239, v239, v27
    v_cvt_pk_bf16_f32 v224, v224, v225
    v_cvt_pk_bf16_f32 v225, v226, v227
    v_cvt_pk_bf16_f32 v226, v228, v229
    v_cvt_pk_bf16_f32 v227, v230, v231
    v_cvt_pk_bf16_f32 v228, v232, v233
    v_cvt_pk_bf16_f32 v229, v234, v235
    v_cvt_pk_bf16_f32 v230, v236, v237
    v_cvt_pk_bf16_f32 v231, v238, v239
    ds_write_b128 v15, v[224:227] offset:8320
    ds_write_b128 v16, v[228:231] offset:8320
    v_mul_f32 v240, v240, v27
    v_mul_f32 v241, v241, v27
    v_mul_f32 v242, v242, v27
    v_mul_f32 v243, v243, v27
    v_mul_f32 v244, v244, v27
    v_mul_f32 v245, v245, v27
    v_mul_f32 v246, v246, v27
    v_mul_f32 v247, v247, v27
    v_mul_f32 v248, v248, v27
    v_mul_f32 v249, v249, v27
    v_mul_f32 v250, v250, v27
    v_mul_f32 v251, v251, v27
    v_mul_f32 v252, v252, v27
    v_mul_f32 v253, v253, v27
    v_mul_f32 v254, v254, v27
    v_mul_f32 v255, v255, v27
    v_cvt_pk_bf16_f32 v240, v240, v241
    v_cvt_pk_bf16_f32 v241, v242, v243
    v_cvt_pk_bf16_f32 v242, v244, v245
    v_cvt_pk_bf16_f32 v243, v246, v247
    v_cvt_pk_bf16_f32 v244, v248, v249
    v_cvt_pk_bf16_f32 v245, v250, v251
    v_cvt_pk_bf16_f32 v246, v252, v253
    v_cvt_pk_bf16_f32 v247, v254, v255
    ds_write_b128 v17, v[240:243] offset:8320
    ds_write_b128 v18, v[244:247] offset:8320
    ds_read_b128 a[160:163], v19 offset:0
    ds_read_b128 a[164:167], v20 offset:1024
    ds_read_b128 a[168:171], v19 offset:2048
    ds_read_b128 a[172:175], v20 offset:3072
    ds_read_b128 a[176:179], v19 offset:4096
    ds_read_b128 a[180:183], v20 offset:5120
    ds_read_b128 a[184:187], v19 offset:6144
    ds_read_b128 a[188:191], v20 offset:7168
    ds_read_b128 a[192:195], v19 offset:8192
    ds_read_b128 a[196:199], v20 offset:9216
    ds_read_b128 a[200:203], v19 offset:10240
    ds_read_b128 a[204:207], v20 offset:11264
    ds_read_b128 a[208:211], v19 offset:12288
    ds_read_b128 a[212:215], v20 offset:13312
    ds_read_b128 a[216:219], v19 offset:14336
    ds_read_b128 a[220:223], v20 offset:15360
    s_waitcnt lgkmcnt(15)
    buffer_store_dwordx4 a[160:163], v21, s[20:23], s28 offen offset:0
    s_waitcnt lgkmcnt(14)
    buffer_store_dwordx4 a[164:167], v21, s[20:23], s28 offen offset:1024
    s_waitcnt lgkmcnt(13)
    buffer_store_dwordx4 a[168:171], v21, s[20:23], s28 offen offset:2048
    s_waitcnt lgkmcnt(12)
    buffer_store_dwordx4 a[172:175], v21, s[20:23], s28 offen offset:3072
    s_waitcnt lgkmcnt(11)
    buffer_store_dwordx4 a[176:179], v21, s[20:23], s29 offen offset:0
    s_waitcnt lgkmcnt(10)
    buffer_store_dwordx4 a[180:183], v21, s[20:23], s29 offen offset:1024
    s_waitcnt lgkmcnt(9)
    buffer_store_dwordx4 a[184:187], v21, s[20:23], s29 offen offset:2048
    s_waitcnt lgkmcnt(8)
    buffer_store_dwordx4 a[188:191], v21, s[20:23], s29 offen offset:3072
    s_waitcnt lgkmcnt(7)
    buffer_store_dwordx4 a[192:195], v21, s[20:23], s30 offen offset:0
    s_waitcnt lgkmcnt(6)
    buffer_store_dwordx4 a[196:199], v21, s[20:23], s30 offen offset:1024
    s_waitcnt lgkmcnt(5)
    buffer_store_dwordx4 a[200:203], v21, s[20:23], s30 offen offset:2048
    s_waitcnt lgkmcnt(4)
    buffer_store_dwordx4 a[204:207], v21, s[20:23], s30 offen offset:3072
    s_waitcnt lgkmcnt(3)
    buffer_store_dwordx4 a[208:211], v21, s[20:23], s31 offen offset:0
    s_waitcnt lgkmcnt(2)
    buffer_store_dwordx4 a[212:215], v21, s[20:23], s31 offen offset:1024
    s_waitcnt lgkmcnt(1)
    buffer_store_dwordx4 a[216:219], v21, s[20:23], s31 offen offset:2048
    s_waitcnt lgkmcnt(0)
    buffer_store_dwordx4 a[220:223], v21, s[20:23], s31 offen offset:3072
L_fbn:
    s_lshl_b32 s41, s41, 1
    s_mov_b32 s42, s43
    s_mov_b32 s46, s47
    s_mov_b32 s50, s51
    s_mov_b32 s43, s44
    s_mov_b32 s47, s48
    s_mov_b32 s51, s52
    s_add_u32 s40, s40, 1
    s_cmp_lt_u32 s40, 3
    s_cbranch_scc1 L_fb
L_exit:
    s_endpgm
.section .rodata,"a"
.p2align 6
.amdhsa_kernel standalone__mha_softmax__near_ridge_kernel
  .amdhsa_next_free_vgpr 512
  .amdhsa_next_free_sgpr 102
  .amdhsa_accum_offset 256
  .amdhsa_group_segment_fixed_size 0
  .amdhsa_kernarg_size 48
  .amdhsa_user_sgpr_count 2
  .amdhsa_user_sgpr_kernarg_segment_ptr 1
  .amdhsa_system_sgpr_workgroup_id_x 1
.end_amdhsa_kernel
```
